```python
import torch

def _softmax(x, axis=-1):
    return torch.softmax(x, dim=axis)
def _gelu(x):
    return torch.nn.functional.gelu(x, approximate="tanh")
def _silu(x):
    return torch.nn.functional.silu(x)
def _sigmoid(x):
    return torch.sigmoid(x)
def _layernorm(x, axis=-1, eps=1e-5):
    m = x.mean(dim=axis, keepdim=True)
    v = x.var(dim=axis, keepdim=True, unbiased=False)
    return (x - m) / torch.sqrt(v + eps)
def _scatter_add(tgt, idx, src, axis=0):
    return tgt.clone().index_add_(axis, idx, src)
def _segment_sum(src, seg, n):
    out = torch.zeros((n,) + src.shape[1:], dtype=src.dtype)
    return out.index_add_(0, seg, src)
def _pad(x, pw):
    flat = tuple(v for pair in reversed(pw) for v in pair)
    return torch.nn.functional.pad(x, flat)

kernel_name = 'sequential_preLN__sliding_block__glu_gated_geglu__prompt'

def setup_inputs():

    _w = (lambda a: (lambda t: t.to(torch.bfloat16) if t.is_floating_point() else t)(torch.as_tensor(a)))
    def _A_setup():
        B, S, D = 1, 2048, 640
        return {
            "x": _w((lambda *s: torch.randn(*s, dtype=torch.bfloat16) * 0.05)(B, S, D)),
            "wqkv": _w((lambda *s: torch.randn(*s, dtype=torch.bfloat16) * 0.05)(D, 3 * D)),
            "wo": _w((lambda *s: torch.randn(*s, dtype=torch.bfloat16) * 0.05)(D, D)),
        }
    _A_in = _A_setup()

    def _B_setup():
        B, S, Dm, Df = 1, 2048, 640, 1536
        return {
            "x": _w((lambda *s: torch.randn(*s, dtype=torch.bfloat16) * 0.05)(B, S, Dm)),
            "w_gate": _w((lambda *s: torch.randn(*s, dtype=torch.bfloat16) * 0.8)(Dm, Df) * (Dm ** -0.5)),
            "w_up": _w((lambda *s: torch.randn(*s, dtype=torch.bfloat16) * 0.8)(Dm, Df) * (Dm ** -0.5)),
            "w_down": _w((lambda *s: torch.randn(*s, dtype=torch.bfloat16) * 0.8)(Df, Dm) * (Df ** -0.5)),
        }
    _B_in = _B_setup()

    return {
        "A_x": _A_in["x"],
        "A_wqkv": _A_in["wqkv"],
        "A_wo": _A_in["wo"],
        "B_x": _B_in["x"],
        "B_w_gate": _B_in["w_gate"],
        "B_w_up": _B_in["w_up"],
        "B_w_down": _B_in["w_down"],
    }

def reference(A_x, A_wqkv, A_wo, B_x, B_w_gate, B_w_up, B_w_down):
    def _A_ref(x, wqkv, wo):
        B, S, D = x.shape
        H = 32; Dh = D // H; W = 256
        qkv = (lambda x, *d: x.permute(*d))((x @ wqkv).reshape(B, S, 3, H, Dh), 2, 0, 3, 1, 4)
        q, k, v = qkv[0], qkv[1], qkv[2]
        scores = torch.einsum("bhqd,bhkd->bhqk", q, k) * (Dh ** -0.5)
        idx = torch.arange(S)
        mask = (idx[:, None] - idx[None, :] >= 0) & (idx[:, None] - idx[None, :] < W)
        scores = torch.where(mask[None, None], scores, -1e9)
        p = _softmax(scores, axis=-1)
        o = torch.einsum("bhqk,bhkd->bhqd", p, v)
        return (lambda x, *d: x.permute(*d))(o, 0, 2, 1, 3).reshape(B, S, D) @ wo

    def _B_ref(x, w_gate, w_up, w_down):
        g = torch.einsum("bsd,df->bsf", x, w_gate)
        u = torch.einsum("bsd,df->bsf", x, w_up)
        h = _gelu(g) * u
        return torch.einsum("bsf,fd->bsd", h, w_down)

    x = A_x
    h = x + _A_ref(_layernorm(x, axis=-1), A_wqkv, A_wo)
    h2 = h + _B_ref(_layernorm(h, axis=-1), B_w_gate, B_w_up, B_w_down)
    return h2
```

```asm
; @launch kernel=ka_kernel grid=(256,1,1) block=(512,1,1) lds=163840
; @launch kernel=kb_kernel grid=(256,1,1) block=(512,1,1) lds=163840
.amdgcn_target "amdgcn-amd-amdhsa--gfx950"
.text
.globl ka_kernel
.p2align 8
.type ka_kernel,@function
ka_kernel:
  s_cmp_ge_u32 s2, 256
  s_cbranch_scc1 L_exit_ka_kernel
  s_load_dwordx16 s[4:19], s[0:1], 0
  s_getpc_b64 s[70:71]
L_tpc_ka_kernel:
  v_lshlrev_b32 v5, 7, v0
  v_min_u32 v5, L_end_of_code-L_tpc_ka_kernel-4, v5
  v_cmp_gt_u32 vcc, 128, v0
  s_nop 1
  s_and_saveexec_b64 s[72:73], vcc
  s_nop 1
  s_cbranch_execz L_tca_ka_kernel
  global_load_dword v255, v5, s[70:71]
L_tca_ka_kernel:
  s_mov_b64 exec, -1
  s_load_dwordx4 s[20:23], s[0:1], 64
  s_memrealtime s[96:97]
  v_and_b32 v1, 63, v0
  v_lshrrev_b32 v2, 6, v0
  s_nop 0
  v_readfirstlane_b32 s3, v2
  v_lshlrev_b32 v2, 4, v1
  s_mov_b32 s94, 0x3f803f80
  s_mov_b32 s95, 0
  s_mov_b32 s93, 0xfffffffe
  s_waitcnt lgkmcnt(0)
  s_mov_b32 s91, s96
  s_mov_b32 s24, s4
  s_and_b32 s25, s5, 0xffff
  s_mov_b32 s26, 2621440
  s_mov_b32 s27, 0x20000
  s_mov_b32 s28, s6
  s_and_b32 s29, s7, 0xffff
  s_mov_b32 s30, 2457600
  s_mov_b32 s31, 0x20000
  s_mov_b32 s32, s22
  s_and_b32 s33, s23, 0xffff
  s_mov_b32 s34, 34603008
  s_mov_b32 s35, 0x20000
  s_mov_b32 s36, s18
  s_and_b32 s37, s19, 0xffff
  s_mov_b32 s38, 2621440
  s_mov_b32 s39, 0x20000
  s_mov_b32 s48, s20
  s_and_b32 s49, s21, 0xffff
  s_mov_b32 s50, 256
  s_mov_b32 s51, 0x20000
  s_lshl_b32 s52, s2, 3
  s_or_b32 s52, s52, s3
  s_cmp_lg_u32 s52, 2047
  s_cbranch_scc1 L_nonce_done
  s_or_b32 s52, s91, 1
  s_mov_b64 exec, 1
  v_mov_b32 v3, s52
  buffer_store_dword v3, off, s[48:51], 0 sc1
  s_mov_b64 exec, -1
  s_nop 1
L_nonce_done:
  s_cmp_ge_u32 s2, 240
  s_cbranch_scc1 L_idle
  s_and_b32 s52, s2, 7
  s_lshr_b32 s53, s2, 3
  s_and_b32 s54, s52, 1
  s_mul_i32 s54, s54, 30
  s_add_u32 s54, s54, s53
  s_lshr_b32 s56, s54, 2
  s_and_b32 s55, s54, 3
  s_lshr_b32 s57, s52, 1
  s_lshl_b32 s57, s57, 2
  s_add_u32 s57, s57, s55
  s_lshr_b32 s58, s52, 1
  s_mul_i32 s58, s58, 5
  s_lshr_b32 s58, s58, 1
  s_and_b32 s53, s52, 1
  s_mul_i32 s53, s53, 5
  s_add_u32 s58, s58, s53
  s_cmp_ge_u32 s58, 10
  s_cselect_b32 s53, 10, 0
  s_sub_u32 s58, s58, s53
  s_mov_b32 s61, s55
  s_and_b32 s59, s3, 3
  s_lshr_b32 s60, s3, 2
  v_lshrrev_b32 v5, 3, v1
  s_lshl_b32 s52, s3, 3
  v_add_u32 v5, s52, v5
  v_bfe_u32 v6, v5, 1, 3
  v_and_b32 v7, 7, v1
  v_xor_b32 v6, v6, v7
  v_mul_u32_u24 v5, 1280, v5
  v_lshl_add_u32 v3, v6, 4, v5
  v_lshrrev_b32 v5, 4, v1
  v_lshlrev_b32 v6, 2, v5
  v_and_b32 v7, 15, v1
  v_xor_b32 v6, v6, v7
  v_add_u32 v5, s52, v5
  v_mul_u32_u24 v5, 3840, v5
  v_lshl_add_u32 v4, v6, 4, v5
  s_mul_i32 s62, s57, 81920
  s_lshl_b32 s63, s56, 8
  s_lshl_b32 s64, s3, 10
  s_lshl_b32 s65, s3, 11
  s_add_u32 s65, s65, 16384
  s_add_u32 s66, s58, 0
  s_lshl_b32 s100, s66, 7
  s_add_u32 s100, s100, s62
  s_add_u32 m0, s64, 0
  s_nop 0
  buffer_load_dwordx4 v3, s[24:27], s100 offen lds
  s_lshl_b32 s100, s66, 7
  s_add_u32 s100, s100, s62
  s_add_u32 s100, s100, 1310720
  s_add_u32 m0, s64, 8192
  s_nop 0
  buffer_load_dwordx4 v3, s[24:27], s100 offen lds
  s_mul_i32 s100, s66, 245760
  s_add_u32 s100, s100, s63
  s_add_u32 m0, s65, 0
  s_nop 0
  buffer_load_dwordx4 v4, s[28:31], s100 offen lds
  s_mul_i32 s100, s66, 245760
  s_add_u32 s100, s100, s63
  s_add_u32 s100, s100, 15360
  s_add_u32 m0, s65, 1024
  s_nop 0
  buffer_load_dwordx4 v4, s[28:31], s100 offen lds
  s_add_u32 s67, s58, 1
  s_lshl_b32 s100, s67, 7
  s_add_u32 s100, s100, s62
  s_add_u32 m0, s64, 32768
  s_nop 0
  buffer_load_dwordx4 v3, s[24:27], s100 offen lds
  s_lshl_b32 s100, s67, 7
  s_add_u32 s100, s100, s62
  s_add_u32 s100, s100, 1310720
  s_add_u32 m0, s64, 40960
  s_nop 0
  buffer_load_dwordx4 v3, s[24:27], s100 offen lds
  s_mul_i32 s100, s67, 245760
  s_add_u32 s100, s100, s63
  s_add_u32 m0, s65, 32768
  s_nop 0
  buffer_load_dwordx4 v4, s[28:31], s100 offen lds
  s_mul_i32 s100, s67, 245760
  s_add_u32 s100, s100, s63
  s_add_u32 s100, s100, 15360
  s_add_u32 m0, s65, 33792
  s_nop 0
  buffer_load_dwordx4 v4, s[28:31], s100 offen lds
  s_add_u32 s68, s58, 2
  s_add_u32 s69, s58, 3
  s_cmp_ge_u32 s69, 10
  s_cselect_b32 s52, 10, 0
  s_sub_u32 s69, s69, s52
  s_add_u32 s70, s58, 4
  s_cmp_ge_u32 s70, 10
  s_cselect_b32 s52, 10, 0
  s_sub_u32 s70, s70, s52
  s_add_u32 s71, s58, 5
  s_cmp_ge_u32 s71, 10
  s_cselect_b32 s52, 10, 0
  s_sub_u32 s71, s71, s52
  s_add_u32 s72, s58, 6
  s_cmp_ge_u32 s72, 10
  s_cselect_b32 s52, 10, 0
  s_sub_u32 s72, s72, s52
  s_add_u32 s73, s58, 7
  s_cmp_ge_u32 s73, 10
  s_cselect_b32 s52, 10, 0
  s_sub_u32 s73, s73, s52
  s_add_u32 s74, s58, 8
  s_cmp_ge_u32 s74, 10
  s_cselect_b32 s52, 10, 0
  s_sub_u32 s74, s74, s52
  s_add_u32 s75, s58, 9
  s_cmp_ge_u32 s75, 10
  s_cselect_b32 s52, 10, 0
  s_sub_u32 s75, s75, s52
  s_and_b32 s59, s3, 3
  s_lshr_b32 s60, s3, 2
  v_and_b32 v20, 31, v1
  s_lshl_b32 s52, s60, 5
  v_add_u32 v20, s52, v20
  v_bfe_u32 v21, v20, 1, 3
  v_lshrrev_b32 v22, 5, v1
  v_xor_b32 v21, v21, v22
  v_lshlrev_b32 v20, 7, v20
  v_lshl_add_u32 v20, v21, 4, v20
  v_bfe_u32 v21, v1, 2, 2
  v_lshrrev_b32 v22, 5, v1
  v_lshl_add_u32 v22, v22, 3, v21
  v_lshlrev_b32 v22, 8, v22
  v_xor_b32 v21, s59, v21
  v_lshl_add_u32 v22, v21, 6, v22
  v_bfe_u32 v21, v1, 4, 1
  v_lshl_add_u32 v22, v21, 5, v22
  v_and_b32 v21, 3, v1
  v_lshl_add_u32 v22, v21, 3, v22
  v_add_u32 v22, 16384, v22
  s_add_u32 s52, s59, 0
  s_and_b32 s52, s52, 3
  s_lshl_b32 s53, s52, 5
  v_xor_b32 v5, s53, v20
  v_add_u32 v112, 65536, v5
  s_lshl_b32 s53, s52, 12
  v_add_u32 v9, s53, v22
  v_add_u32 v116, 65536, v9
  s_add_u32 s52, s59, 1
  s_and_b32 s52, s52, 3
  s_lshl_b32 s53, s52, 5
  v_xor_b32 v6, s53, v20
  v_add_u32 v113, 65536, v6
  s_lshl_b32 s53, s52, 12
  v_add_u32 v10, s53, v22
  v_add_u32 v117, 65536, v10
  s_add_u32 s52, s59, 2
  s_and_b32 s52, s52, 3
  s_lshl_b32 s53, s52, 5
  v_xor_b32 v7, s53, v20
  v_add_u32 v114, 65536, v7
  s_lshl_b32 s53, s52, 12
  v_add_u32 v11, s53, v22
  v_add_u32 v118, 65536, v11
  s_add_u32 s52, s59, 3
  s_and_b32 s52, s52, 3
  s_lshl_b32 s53, s52, 5
  v_xor_b32 v8, s53, v20
  v_add_u32 v115, 65536, v8
  s_lshl_b32 s53, s52, 12
  v_add_u32 v12, s53, v22
  v_add_u32 v119, 65536, v12
  s_lshl_b32 s100, s68, 7
  s_add_u32 s100, s100, s62
  s_add_u32 m0, s64, 65536
  s_nop 0
  buffer_load_dwordx4 v3, s[24:27], s100 offen lds
  s_lshl_b32 s100, s68, 7
  s_add_u32 s100, s100, s62
  s_add_u32 s100, s100, 1310720
  s_add_u32 m0, s64, 73728
  s_nop 0
  buffer_load_dwordx4 v3, s[24:27], s100 offen lds
  s_mul_i32 s100, s68, 245760
  s_add_u32 s100, s100, s63
  s_add_u32 m0, s65, 65536
  s_nop 0
  buffer_load_dwordx4 v4, s[28:31], s100 offen lds
  s_mul_i32 s100, s68, 245760
  s_add_u32 s100, s100, s63
  s_add_u32 s100, s100, 15360
  s_add_u32 m0, s65, 66560
  s_nop 0
  buffer_load_dwordx4 v4, s[28:31], s100 offen lds
  s_mul_i32 s76, s57, 2560
  s_add_u32 s77, s76, 40960
  s_lshl_b32 s78, s59, 3
  s_lshl_b32 s53, s56, 5
  s_add_u32 s78, s78, s53
  s_lshl_b32 s79, s60, 1
  s_mov_b32 s80, 81920
  s_lshl_b32 s52, s60, 2
  s_add_u32 s61, s61, s52
  s_cmp_ge_u32 s3, 4
  s_cbranch_scc1 s1G1_1
  s_waitcnt vmcnt(8)
  s_barrier
  ds_read_b64_tr_b16 v[64:65], v9 offset:0
  ds_read_b64_tr_b16 v[66:67], v9 offset:1024
  ds_read_b128 v[80:83], v5 offset:0
  ds_read_b128 v[96:99], v5 offset:8192
  ds_read_b64_tr_b16 v[68:69], v10 offset:0
  ds_read_b64_tr_b16 v[70:71], v10 offset:1024
  ds_read_b128 v[84:87], v6 offset:0
  ds_read_b128 v[100:103], v6 offset:8192
  s_waitcnt lgkmcnt(4)
  v_mfma_f32_32x32x16_bf16 v[32:47], v[64:67], v[80:83], 0
  ds_read_b64_tr_b16 v[72:73], v11 offset:0
  ds_read_b64_tr_b16 v[74:75], v11 offset:1024
  ds_read_b128 v[88:91], v7 offset:0
  ds_read_b128 v[104:107], v7 offset:8192
  s_lshl_b32 s100, s69, 7
  s_add_u32 s100, s100, s62
  s_add_u32 m0, s64, 98304
  s_nop 0
  buffer_load_dwordx4 v3, s[24:27], s100 offen lds
  v_mfma_f32_32x32x16_bf16 v[48:63], v[64:67], v[96:99], 0
  s_cmp_lg_u32 s61, 0
  s_cbranch_scc1 csp_3
  v_mov_b32 v120, 0
  v_mov_b32 v121, 0
  v_dot2c_f32_bf16 v120, s94, v64
  v_dot2c_f32_bf16 v121, s94, v65
  v_dot2c_f32_bf16 v120, s94, v66
  v_dot2c_f32_bf16 v121, s94, v67
csp_3:
  s_lshl_b32 s100, s69, 7
  s_add_u32 s100, s100, s62
  s_add_u32 s100, s100, 1310720
  s_add_u32 m0, s64, 106496
  s_nop 0
  buffer_load_dwordx4 v3, s[24:27], s100 offen lds
  s_waitcnt lgkmcnt(4)
  v_mfma_f32_32x32x16_bf16 v[32:47], v[68:71], v[84:87], v[32:47]
  ds_read_b64_tr_b16 v[76:77], v12 offset:0
  ds_read_b64_tr_b16 v[78:79], v12 offset:1024
  ds_read_b128 v[92:95], v8 offset:0
  ds_read_b128 v[108:111], v8 offset:8192
  s_mul_i32 s100, s69, 245760
  s_add_u32 s100, s100, s63
  s_add_u32 m0, s65, 98304
  s_nop 0
  buffer_load_dwordx4 v4, s[28:31], s100 offen lds
  v_mfma_f32_32x32x16_bf16 v[48:63], v[68:71], v[100:103], v[48:63]
  s_cmp_lg_u32 s61, 0
  s_cbranch_scc1 csp_4
  v_dot2c_f32_bf16 v120, s94, v68
  v_dot2c_f32_bf16 v121, s94, v69
  v_dot2c_f32_bf16 v120, s94, v70
  v_dot2c_f32_bf16 v121, s94, v71
csp_4:
  s_mul_i32 s100, s69, 245760
  s_add_u32 s100, s100, s63
  s_add_u32 s100, s100, 15360
  s_add_u32 m0, s65, 99328
  s_nop 0
  buffer_load_dwordx4 v4, s[28:31], s100 offen lds
  s_waitcnt vmcnt(8)
  s_barrier
  s_waitcnt lgkmcnt(4)
  v_mfma_f32_32x32x16_bf16 v[32:47], v[72:75], v[88:91], v[32:47]
  ds_read_b64_tr_b16 v[64:65], v9 offset:32768
  ds_read_b64_tr_b16 v[66:67], v9 offset:33792
  ds_read_b128 v[80:83], v5 offset:32768
  ds_read_b128 v[96:99], v5 offset:40960
  buffer_load_dword v124, off, s[48:51], 0 sc1
  v_mfma_f32_32x32x16_bf16 v[48:63], v[72:75], v[104:107], v[48:63]
  s_cmp_lg_u32 s61, 0
  s_cbranch_scc1 csp_5
  v_dot2c_f32_bf16 v120, s94, v72
  v_dot2c_f32_bf16 v121, s94, v73
  v_dot2c_f32_bf16 v120, s94, v74
  v_dot2c_f32_bf16 v121, s94, v75
csp_5:
  s_waitcnt lgkmcnt(4)
  v_mfma_f32_32x32x16_bf16 v[32:47], v[76:79], v[92:95], v[32:47]
  ds_read_b64_tr_b16 v[68:69], v10 offset:32768
  ds_read_b64_tr_b16 v[70:71], v10 offset:33792
  ds_read_b128 v[84:87], v6 offset:32768
  ds_read_b128 v[100:103], v6 offset:40960
  v_mfma_f32_32x32x16_bf16 v[48:63], v[76:79], v[108:111], v[48:63]
  s_cmp_lg_u32 s61, 0
  s_cbranch_scc1 csp_6
  v_dot2c_f32_bf16 v120, s94, v76
  v_dot2c_f32_bf16 v121, s94, v77
  v_dot2c_f32_bf16 v120, s94, v78
  v_dot2c_f32_bf16 v121, s94, v79
csp_6:
  s_waitcnt lgkmcnt(4)
  v_mfma_f32_32x32x16_bf16 v[32:47], v[64:67], v[80:83], v[32:47]
  ds_read_b64_tr_b16 v[72:73], v11 offset:32768
  ds_read_b64_tr_b16 v[74:75], v11 offset:33792
  ds_read_b128 v[88:91], v7 offset:32768
  ds_read_b128 v[104:107], v7 offset:40960
  v_mfma_f32_32x32x16_bf16 v[48:63], v[64:67], v[96:99], v[48:63]
  s_cmp_lg_u32 s61, 1
  s_cbranch_scc1 csp_7
  v_mov_b32 v120, 0
  v_mov_b32 v121, 0
  v_dot2c_f32_bf16 v120, s94, v64
  v_dot2c_f32_bf16 v121, s94, v65
  v_dot2c_f32_bf16 v120, s94, v66
  v_dot2c_f32_bf16 v121, s94, v67
csp_7:
  s_waitcnt lgkmcnt(4)
  v_mfma_f32_32x32x16_bf16 v[32:47], v[68:71], v[84:87], v[32:47]
  ds_read_b64_tr_b16 v[76:77], v12 offset:32768
  ds_read_b64_tr_b16 v[78:79], v12 offset:33792
  ds_read_b128 v[92:95], v8 offset:32768
  ds_read_b128 v[108:111], v8 offset:40960
  v_mfma_f32_32x32x16_bf16 v[48:63], v[68:71], v[100:103], v[48:63]
  s_cmp_lg_u32 s61, 1
  s_cbranch_scc1 csp_8
  v_dot2c_f32_bf16 v120, s94, v68
  v_dot2c_f32_bf16 v121, s94, v69
  v_dot2c_f32_bf16 v120, s94, v70
  v_dot2c_f32_bf16 v121, s94, v71
csp_8:
  s_waitcnt vmcnt(5)
  s_barrier
  s_waitcnt lgkmcnt(4)
  v_mfma_f32_32x32x16_bf16 v[32:47], v[72:75], v[88:91], v[32:47]
  ds_read_b64_tr_b16 v[64:65], v116 offset:0
  ds_read_b64_tr_b16 v[66:67], v116 offset:1024
  ds_read_b128 v[80:83], v112 offset:0
  ds_read_b128 v[96:99], v112 offset:8192
  s_lshl_b32 s100, s70, 7
  s_add_u32 s100, s100, s62
  s_add_u32 m0, s64, 0
  s_nop 0
  buffer_load_dwordx4 v3, s[24:27], s100 offen lds
  v_mfma_f32_32x32x16_bf16 v[48:63], v[72:75], v[104:107], v[48:63]
  s_cmp_lg_u32 s61, 1
  s_cbranch_scc1 csp_9
  v_dot2c_f32_bf16 v120, s94, v72
  v_dot2c_f32_bf16 v121, s94, v73
  v_dot2c_f32_bf16 v120, s94, v74
  v_dot2c_f32_bf16 v121, s94, v75
csp_9:
  s_lshl_b32 s100, s70, 7
  s_add_u32 s100, s100, s62
  s_add_u32 s100, s100, 1310720
  s_add_u32 m0, s64, 8192
  s_nop 0
  buffer_load_dwordx4 v3, s[24:27], s100 offen lds
  s_waitcnt lgkmcnt(4)
  v_mfma_f32_32x32x16_bf16 v[32:47], v[76:79], v[92:95], v[32:47]
  ds_read_b64_tr_b16 v[68:69], v117 offset:0
  ds_read_b64_tr_b16 v[70:71], v117 offset:1024
  ds_read_b128 v[84:87], v113 offset:0
  ds_read_b128 v[100:103], v113 offset:8192
  s_mul_i32 s100, s70, 245760
  s_add_u32 s100, s100, s63
  s_add_u32 m0, s65, 0
  s_nop 0
  buffer_load_dwordx4 v4, s[28:31], s100 offen lds
  v_mfma_f32_32x32x16_bf16 v[48:63], v[76:79], v[108:111], v[48:63]
  s_cmp_lg_u32 s61, 1
  s_cbranch_scc1 csp_10
  v_dot2c_f32_bf16 v120, s94, v76
  v_dot2c_f32_bf16 v121, s94, v77
  v_dot2c_f32_bf16 v120, s94, v78
  v_dot2c_f32_bf16 v121, s94, v79
csp_10:
  s_mul_i32 s100, s70, 245760
  s_add_u32 s100, s100, s63
  s_add_u32 s100, s100, 15360
  s_add_u32 m0, s65, 1024
  s_nop 0
  buffer_load_dwordx4 v4, s[28:31], s100 offen lds
  s_waitcnt lgkmcnt(4)
  v_mfma_f32_32x32x16_bf16 v[32:47], v[64:67], v[80:83], v[32:47]
  ds_read_b64_tr_b16 v[72:73], v118 offset:0
  ds_read_b64_tr_b16 v[74:75], v118 offset:1024
  ds_read_b128 v[88:91], v114 offset:0
  ds_read_b128 v[104:107], v114 offset:8192
  v_mfma_f32_32x32x16_bf16 v[48:63], v[64:67], v[96:99], v[48:63]
  s_cmp_lg_u32 s61, 2
  s_cbranch_scc1 csp_11
  v_mov_b32 v120, 0
  v_mov_b32 v121, 0
  v_dot2c_f32_bf16 v120, s94, v64
  v_dot2c_f32_bf16 v121, s94, v65
  v_dot2c_f32_bf16 v120, s94, v66
  v_dot2c_f32_bf16 v121, s94, v67
csp_11:
  s_waitcnt lgkmcnt(4)
  v_mfma_f32_32x32x16_bf16 v[32:47], v[68:71], v[84:87], v[32:47]
  ds_read_b64_tr_b16 v[76:77], v119 offset:0
  ds_read_b64_tr_b16 v[78:79], v119 offset:1024
  ds_read_b128 v[92:95], v115 offset:0
  ds_read_b128 v[108:111], v115 offset:8192
  v_mfma_f32_32x32x16_bf16 v[48:63], v[68:71], v[100:103], v[48:63]
  s_cmp_lg_u32 s61, 2
  s_cbranch_scc1 csp_12
  v_dot2c_f32_bf16 v120, s94, v68
  v_dot2c_f32_bf16 v121, s94, v69
  v_dot2c_f32_bf16 v120, s94, v70
  v_dot2c_f32_bf16 v121, s94, v71
csp_12:
  s_waitcnt vmcnt(5)
  s_waitcnt vmcnt(4)
  s_nop 7
nchk_13:
  v_readfirstlane_b32 s92, v124
  s_nop 1
  s_cmp_lg_u32 s92, 0
  s_nop 1
  s_cbranch_scc1 nok_14
  s_add_u32 s95, s95, 1
  s_cmp_gt_u32 s95, 20000
  s_cbranch_scc1 nok_14
  s_sleep 8
  s_waitcnt vmcnt(0) lgkmcnt(0)
  buffer_load_dword v124, off, s[48:51], 0 sc1
  s_waitcnt vmcnt(0)
  s_branch nchk_13
nok_14:
  s_barrier
  s_min_u32 s55, s3, 6
  s_mul_i32 s52, s2, 7
  s_add_u32 s52, s52, s55
  s_add_u32 s52, s52, 0
  s_min_u32 s52, s52, 1639
  s_lshl_b32 s55, s3, 12
  s_add_u32 s55, s55, 131072
  v_lshrrev_b32 v14, 3, v1
  v_and_b32 v15, 7, v1
  s_cmp_ge_u32 s52, 680
  s_nop 1
  s_cbranch_scc1 s0i4_16
  s_cmp_ge_u32 s52, 200
  s_cbranch_scc1 s0i5_17
  s_mov_b32 s40, s8
  s_and_b32 s41, s9, 0xffff
  s_mov_b32 s42, 819200
  s_mov_b32 s43, 0x20000
  s_mul_i32 s87, s52, 6554
  s_lshr_b32 s87, s87, 16
  s_mul_i32 s88, s87, 10
  s_sub_u32 s88, s52, s88
  s_lshl_b32 s54, s88, 7
  s_cmp_ge_u32 s87, 16
  s_cbranch_scc1 s0ig_18
  s_mul_i32 s53, s87, 51200
  s_add_u32 s53, s53, s54
  v_mul_u32_u24 v14, 1280, v14
  v_lshl_add_u32 v14, v15, 4, v14
  s_add_u32 m0, s55, 0
  s_add_u32 s54, s53, 0
  buffer_load_dwordx4 v14, s[40:43], s54 offen lds
  s_add_u32 m0, s55, 1024
  s_add_u32 s54, s53, 10240
  buffer_load_dwordx4 v14, s[40:43], s54 offen lds
  s_add_u32 m0, s55, 2048
  s_add_u32 s54, s53, 25600
  buffer_load_dwordx4 v14, s[40:43], s54 offen lds
  s_add_u32 m0, s55, 3072
  s_add_u32 s54, s53, 35840
  buffer_load_dwordx4 v14, s[40:43], s54 offen lds
  s_branch s0i_15
s0ig_18:
  s_sub_u32 s53, s87, 16
  s_mul_i32 s53, s53, 204800
  s_add_u32 s53, s53, s54
  s_add_u32 s53, s53, 20480
  v_lshlrev_b32 v15, 4, v15
  v_and_b32 v14, 3, v14
  v_mul_u32_u24 v14, 1280, v14
  v_add_u32 v15, v15, v14
  v_lshrrev_b32 v14, 5, v1
  v_mul_u32_u24 v14, 25600, v14
  v_add_u32 v14, v14, v15
  s_add_u32 m0, s55, 0
  s_nop 0
  buffer_load_dwordx4 v14, s[40:43], s53 offen lds
  s_add_u32 s53, s53, 51200
  s_add_u32 m0, s55, 1024
  s_nop 0
  buffer_load_dwordx4 v14, s[40:43], s53 offen lds
  s_add_u32 s53, s53, 51200
  s_add_u32 m0, s55, 2048
  s_nop 0
  buffer_load_dwordx4 v14, s[40:43], s53 offen lds
  s_add_u32 s53, s53, 51200
  s_add_u32 m0, s55, 3072
  s_nop 0
  buffer_load_dwordx4 v14, s[40:43], s53 offen lds
  s_branch s0i_15
s0i5_17:
  s_mov_b32 s40, s16
  s_and_b32 s41, s17, 0xffff
  s_mov_b32 s42, 1966080
  s_mov_b32 s43, 0x20000
  s_sub_u32 s52, s52, 200
  s_mul_i32 s87, s52, 6554
  s_lshr_b32 s87, s87, 16
  s_mul_i32 s88, s87, 10
  s_sub_u32 s88, s52, s88
  s_mul_i32 s53, s87, 40960
  s_lshl_b32 s54, s88, 7
  s_add_u32 s53, s53, s54
  v_mul_u32_u24 v14, 1280, v14
  v_lshl_add_u32 v14, v15, 4, v14
  s_add_u32 m0, s55, 0
  s_nop 0
  buffer_load_dwordx4 v14, s[40:43], s53 offen lds
  s_add_u32 s53, s53, 10240
  s_add_u32 m0, s55, 1024
  s_nop 0
  buffer_load_dwordx4 v14, s[40:43], s53 offen lds
  s_add_u32 s53, s53, 10240
  s_add_u32 m0, s55, 2048
  s_nop 0
  buffer_load_dwordx4 v14, s[40:43], s53 offen lds
  s_add_u32 s53, s53, 10240
  s_add_u32 m0, s55, 3072
  s_nop 0
  buffer_load_dwordx4 v14, s[40:43], s53 offen lds
  s_branch s0i_15
s0i4_16:
  s_sub_u32 s52, s52, 680
  s_mul_i32 s87, s52, 2731
  s_lshr_b32 s87, s87, 16
  s_mul_i32 s88, s87, 24
  s_sub_u32 s88, s52, s88
  s_mul_i32 s53, s87, 49152
  s_lshl_b32 s54, s88, 7
  s_add_u32 s53, s53, s54
  s_add_u32 s54, s53, 24576
  v_mul_u32_u24 v14, 3072, v14
  v_lshl_add_u32 v14, v15, 4, v14
  s_mov_b32 s40, s12
  s_and_b32 s41, s13, 0xffff
  s_mov_b32 s42, 1966080
  s_mov_b32 s43, 0x20000
  s_add_u32 m0, s55, 0
  s_nop 0
  buffer_load_dwordx4 v14, s[40:43], s53 offen lds
  s_add_u32 m0, s55, 1024
  s_nop 0
  buffer_load_dwordx4 v14, s[40:43], s54 offen lds
  s_mov_b32 s40, s14
  s_and_b32 s41, s15, 0xffff
  s_mov_b32 s42, 1966080
  s_mov_b32 s43, 0x20000
  s_add_u32 m0, s55, 2048
  s_nop 0
  buffer_load_dwordx4 v14, s[40:43], s53 offen lds
  s_add_u32 m0, s55, 3072
  s_nop 0
  buffer_load_dwordx4 v14, s[40:43], s54 offen lds
s0i_15:
  s_waitcnt lgkmcnt(4)
  v_mfma_f32_32x32x16_bf16 v[32:47], v[72:75], v[88:91], v[32:47]
  ds_read_b64_tr_b16 v[64:65], v116 offset:32768
  ds_read_b64_tr_b16 v[66:67], v116 offset:33792
  ds_read_b128 v[80:83], v112 offset:32768
  ds_read_b128 v[96:99], v112 offset:40960
  s_lshl_b32 s100, s71, 7
  s_add_u32 s100, s100, s62
  s_add_u32 m0, s64, 32768
  s_nop 0
  buffer_load_dwordx4 v3, s[24:27], s100 offen lds
  v_mfma_f32_32x32x16_bf16 v[48:63], v[72:75], v[104:107], v[48:63]
  s_cmp_lg_u32 s61, 2
  s_cbranch_scc1 csp_19
  v_dot2c_f32_bf16 v120, s94, v72
  v_dot2c_f32_bf16 v121, s94, v73
  v_dot2c_f32_bf16 v120, s94, v74
  v_dot2c_f32_bf16 v121, s94, v75
csp_19:
  s_lshl_b32 s100, s71, 7
  s_add_u32 s100, s100, s62
  s_add_u32 s100, s100, 1310720
  s_add_u32 m0, s64, 40960
  s_nop 0
  buffer_load_dwordx4 v3, s[24:27], s100 offen lds
  s_waitcnt lgkmcnt(4)
  v_mfma_f32_32x32x16_bf16 v[32:47], v[76:79], v[92:95], v[32:47]
  ds_read_b64_tr_b16 v[68:69], v117 offset:32768
  ds_read_b64_tr_b16 v[70:71], v117 offset:33792
  ds_read_b128 v[84:87], v113 offset:32768
  ds_read_b128 v[100:103], v113 offset:40960
  s_mul_i32 s100, s71, 245760
  s_add_u32 s100, s100, s63
  s_add_u32 m0, s65, 32768
  s_nop 0
  buffer_load_dwordx4 v4, s[28:31], s100 offen lds
  v_mfma_f32_32x32x16_bf16 v[48:63], v[76:79], v[108:111], v[48:63]
  s_cmp_lg_u32 s61, 2
  s_cbranch_scc1 csp_20
  v_dot2c_f32_bf16 v120, s94, v76
  v_dot2c_f32_bf16 v121, s94, v77
  v_dot2c_f32_bf16 v120, s94, v78
  v_dot2c_f32_bf16 v121, s94, v79
csp_20:
  s_mul_i32 s100, s71, 245760
  s_add_u32 s100, s100, s63
  s_add_u32 s100, s100, 15360
  s_add_u32 m0, s65, 33792
  s_nop 0
  buffer_load_dwordx4 v4, s[28:31], s100 offen lds
  s_waitcnt lgkmcnt(4)
  v_mfma_f32_32x32x16_bf16 v[32:47], v[64:67], v[80:83], v[32:47]
  ds_read_b64_tr_b16 v[72:73], v118 offset:32768
  ds_read_b64_tr_b16 v[74:75], v118 offset:33792
  ds_read_b128 v[88:91], v114 offset:32768
  ds_read_b128 v[104:107], v114 offset:40960
  v_mfma_f32_32x32x16_bf16 v[48:63], v[64:67], v[96:99], v[48:63]
  s_waitcnt lgkmcnt(4)
  v_mfma_f32_32x32x16_bf16 v[32:47], v[68:71], v[84:87], v[32:47]
  ds_read_b64_tr_b16 v[76:77], v119 offset:32768
  ds_read_b64_tr_b16 v[78:79], v119 offset:33792
  ds_read_b128 v[92:95], v115 offset:32768
  ds_read_b128 v[108:111], v115 offset:40960
  v_mfma_f32_32x32x16_bf16 v[48:63], v[68:71], v[100:103], v[48:63]
  s_waitcnt vmcnt(8)
  s_barrier
  s_cmp_ge_u32 s61, 3
  s_nop 8
  s_cbranch_scc1 csst_21
  v_add_f32 v120, v120, v121
  v_mov_b32 v121, v120
  s_nop 1
  v_permlane32_swap_b32 v120, v121
  v_add_f32 v120, v120, v121
  v_and_b32 v122, 31, v1
  v_lshlrev_b32 v122, 3, v122
  v_mov_b32 v121, s92
  s_add_u32 s52, s58, s61
  s_mul_i32 s52, s52, 15360
  s_lshl_b32 s53, s56, 10
  s_add_u32 s52, s52, s53
  s_lshl_b32 s53, s59, 8
  s_add_u32 s52, s52, s53
  s_add_u32 s52, s52, 34078720
  s_mov_b32 exec_hi, 0
  buffer_store_dwordx2 v[120:121], v122, s[32:35], s52 offen sc1
  s_mov_b64 exec, -1
  s_nop 0
csst_21:
  s_waitcnt lgkmcnt(4)
  v_mfma_f32_32x32x16_bf16 v[32:47], v[72:75], v[88:91], v[32:47]
  ds_read_b64_tr_b16 v[64:65], v9 offset:0
  ds_read_b64_tr_b16 v[66:67], v9 offset:1024
  ds_read_b128 v[80:83], v5 offset:0
  ds_read_b128 v[96:99], v5 offset:8192
  s_lshl_b32 s100, s72, 7
  s_add_u32 s100, s100, s62
  s_add_u32 m0, s64, 65536
  s_nop 0
  buffer_load_dwordx4 v3, s[24:27], s100 offen lds
  v_mfma_f32_32x32x16_bf16 v[48:63], v[72:75], v[104:107], v[48:63]
  s_lshl_b32 s100, s72, 7
  s_add_u32 s100, s100, s62
  s_add_u32 s100, s100, 1310720
  s_add_u32 m0, s64, 73728
  s_nop 0
  buffer_load_dwordx4 v3, s[24:27], s100 offen lds
  s_waitcnt lgkmcnt(4)
  v_mfma_f32_32x32x16_bf16 v[32:47], v[76:79], v[92:95], v[32:47]
  ds_read_b64_tr_b16 v[68:69], v10 offset:0
  ds_read_b64_tr_b16 v[70:71], v10 offset:1024
  ds_read_b128 v[84:87], v6 offset:0
  ds_read_b128 v[100:103], v6 offset:8192
  s_mul_i32 s100, s72, 245760
  s_add_u32 s100, s100, s63
  s_add_u32 m0, s65, 65536
  s_nop 0
  buffer_load_dwordx4 v4, s[28:31], s100 offen lds
  v_mfma_f32_32x32x16_bf16 v[48:63], v[76:79], v[108:111], v[48:63]
  s_mul_i32 s100, s72, 245760
  s_add_u32 s100, s100, s63
  s_add_u32 s100, s100, 15360
  s_add_u32 m0, s65, 66560
  s_nop 0
  buffer_load_dwordx4 v4, s[28:31], s100 offen lds
  s_waitcnt lgkmcnt(4)
  v_mfma_f32_32x32x16_bf16 v[32:47], v[64:67], v[80:83], v[32:47]
  v_lshrrev_b32 v20, 5, v1
  v_add_u32 v20, s78, v20
  v_bfe_u32 v21, v1, 4, 1
  ds_read_b64_tr_b16 v[72:73], v11 offset:0
  ds_read_b64_tr_b16 v[74:75], v11 offset:1024
  ds_read_b128 v[88:91], v7 offset:0
  ds_read_b128 v[104:107], v7 offset:8192
  v_mfma_f32_32x32x16_bf16 v[48:63], v[64:67], v[96:99], v[48:63]
  v_add_u32 v21, s79, v21
  v_mul_u32_u24 v21, 640, v21
  v_and_b32 v22, 15, v1
  s_waitcnt lgkmcnt(4)
  v_mfma_f32_32x32x16_bf16 v[32:47], v[68:71], v[84:87], v[32:47]
  v_add_u32 v23, 0, v20
  v_mul_u32_u24 v24, 0xcccd, v23
  v_lshrrev_b32 v24, 18, v24
  ds_read_b64_tr_b16 v[76:77], v12 offset:0
  ds_read_b64_tr_b16 v[78:79], v12 offset:1024
  ds_read_b128 v[92:95], v8 offset:0
  ds_read_b128 v[108:111], v8 offset:8192
  v_mfma_f32_32x32x16_bf16 v[48:63], v[68:71], v[100:103], v[48:63]
  v_mul_u32_u24 v25, 5, v24
  v_sub_u32 v25, v23, v25
  v_mul_lo_u32 v24, v24, s80
  s_waitcnt vmcnt(4)
  s_barrier
  s_waitcnt lgkmcnt(4)
  v_mfma_f32_32x32x16_bf16 v[32:47], v[72:75], v[88:91], v[32:47]
  v_add_u32 v24, v24, v21
  v_lshl_add_u32 v24, v25, 7, v24
  v_and_b32 v25, 2, v25
  ds_read_b64_tr_b16 v[64:65], v9 offset:32768
  ds_read_b64_tr_b16 v[66:67], v9 offset:33792
  ds_read_b128 v[80:83], v5 offset:32768
  ds_read_b128 v[96:99], v5 offset:40960
  s_lshl_b32 s100, s73, 7
  s_add_u32 s100, s100, s62
  s_add_u32 m0, s64, 98304
  s_nop 0
  buffer_load_dwordx4 v3, s[24:27], s100 offen lds
  v_mfma_f32_32x32x16_bf16 v[48:63], v[72:75], v[104:107], v[48:63]
  v_lshlrev_b32 v25, 2, v25
  v_xor_b32 v25, v25, v22
  v_lshl_add_u32 v16, v25, 3, v24
  s_lshl_b32 s100, s73, 7
  s_add_u32 s100, s100, s62
  s_add_u32 s100, s100, 1310720
  s_add_u32 m0, s64, 106496
  s_nop 0
  buffer_load_dwordx4 v3, s[24:27], s100 offen lds
  s_waitcnt lgkmcnt(4)
  v_mfma_f32_32x32x16_bf16 v[32:47], v[76:79], v[92:95], v[32:47]
  v_add_u32 v23, 2, v20
  v_mul_u32_u24 v24, 0xcccd, v23
  v_lshrrev_b32 v24, 18, v24
  ds_read_b64_tr_b16 v[68:69], v10 offset:32768
  ds_read_b64_tr_b16 v[70:71], v10 offset:33792
  ds_read_b128 v[84:87], v6 offset:32768
  ds_read_b128 v[100:103], v6 offset:40960
  s_mul_i32 s100, s73, 245760
  s_add_u32 s100, s100, s63
  s_add_u32 m0, s65, 98304
  s_nop 0
  buffer_load_dwordx4 v4, s[28:31], s100 offen lds
  v_mfma_f32_32x32x16_bf16 v[48:63], v[76:79], v[108:111], v[48:63]
  v_mul_u32_u24 v25, 5, v24
  v_sub_u32 v25, v23, v25
  v_mul_lo_u32 v24, v24, s80
  s_mul_i32 s100, s73, 245760
  s_add_u32 s100, s100, s63
  s_add_u32 s100, s100, 15360
  s_add_u32 m0, s65, 99328
  s_nop 0
  buffer_load_dwordx4 v4, s[28:31], s100 offen lds
  s_waitcnt lgkmcnt(4)
  v_mfma_f32_32x32x16_bf16 v[32:47], v[64:67], v[80:83], v[32:47]
  v_add_u32 v24, v24, v21
  v_lshl_add_u32 v24, v25, 7, v24
  v_and_b32 v25, 2, v25
  ds_read_b64_tr_b16 v[72:73], v11 offset:32768
  ds_read_b64_tr_b16 v[74:75], v11 offset:33792
  ds_read_b128 v[88:91], v7 offset:32768
  ds_read_b128 v[104:107], v7 offset:40960
  v_mfma_f32_32x32x16_bf16 v[48:63], v[64:67], v[96:99], v[48:63]
  v_lshlrev_b32 v25, 2, v25
  v_xor_b32 v25, v25, v22
  v_lshl_add_u32 v17, v25, 3, v24
  s_waitcnt lgkmcnt(4)
  v_mfma_f32_32x32x16_bf16 v[32:47], v[68:71], v[84:87], v[32:47]
  v_add_u32 v23, 4, v20
  v_mul_u32_u24 v24, 0xcccd, v23
  v_lshrrev_b32 v24, 18, v24
  ds_read_b64_tr_b16 v[76:77], v12 offset:32768
  ds_read_b64_tr_b16 v[78:79], v12 offset:33792
  ds_read_b128 v[92:95], v8 offset:32768
  ds_read_b128 v[108:111], v8 offset:40960
  v_mfma_f32_32x32x16_bf16 v[48:63], v[68:71], v[100:103], v[48:63]
  v_mul_u32_u24 v25, 5, v24
  v_sub_u32 v25, v23, v25
  v_mul_lo_u32 v24, v24, s80
  s_waitcnt vmcnt(4)
  s_barrier
  s_waitcnt lgkmcnt(4)
  v_mfma_f32_32x32x16_bf16 v[32:47], v[72:75], v[88:91], v[32:47]
  v_add_u32 v24, v24, v21
  v_lshl_add_u32 v24, v25, 7, v24
  v_and_b32 v25, 2, v25
  ds_read_b64_tr_b16 v[64:65], v116 offset:0
  ds_read_b64_tr_b16 v[66:67], v116 offset:1024
  ds_read_b128 v[80:83], v112 offset:0
  ds_read_b128 v[96:99], v112 offset:8192
  s_lshl_b32 s100, s74, 7
  s_add_u32 s100, s100, s62
  s_add_u32 m0, s64, 0
  s_nop 0
  buffer_load_dwordx4 v3, s[24:27], s100 offen lds
  v_mfma_f32_32x32x16_bf16 v[48:63], v[72:75], v[104:107], v[48:63]
  v_lshlrev_b32 v25, 2, v25
  v_xor_b32 v25, v25, v22
  v_lshl_add_u32 v18, v25, 3, v24
  s_lshl_b32 s100, s74, 7
  s_add_u32 s100, s100, s62
  s_add_u32 s100, s100, 1310720
  s_add_u32 m0, s64, 8192
  s_nop 0
  buffer_load_dwordx4 v3, s[24:27], s100 offen lds
  s_waitcnt lgkmcnt(4)
  v_mfma_f32_32x32x16_bf16 v[32:47], v[76:79], v[92:95], v[32:47]
  v_add_u32 v23, 6, v20
  v_mul_u32_u24 v24, 0xcccd, v23
  v_lshrrev_b32 v24, 18, v24
  ds_read_b64_tr_b16 v[68:69], v117 offset:0
  ds_read_b64_tr_b16 v[70:71], v117 offset:1024
  ds_read_b128 v[84:87], v113 offset:0
  ds_read_b128 v[100:103], v113 offset:8192
  s_mul_i32 s100, s74, 245760
  s_add_u32 s100, s100, s63
  s_add_u32 m0, s65, 0
  s_nop 0
  buffer_load_dwordx4 v4, s[28:31], s100 offen lds
  v_mfma_f32_32x32x16_bf16 v[48:63], v[76:79], v[108:111], v[48:63]
  v_mul_u32_u24 v25, 5, v24
  v_sub_u32 v25, v23, v25
  v_mul_lo_u32 v24, v24, s80
  s_mul_i32 s100, s74, 245760
  s_add_u32 s100, s100, s63
  s_add_u32 s100, s100, 15360
  s_add_u32 m0, s65, 1024
  s_nop 0
  buffer_load_dwordx4 v4, s[28:31], s100 offen lds
  s_waitcnt lgkmcnt(4)
  v_mfma_f32_32x32x16_bf16 v[32:47], v[64:67], v[80:83], v[32:47]
  v_add_u32 v24, v24, v21
  v_lshl_add_u32 v24, v25, 7, v24
  v_and_b32 v25, 2, v25
  ds_read_b64_tr_b16 v[72:73], v118 offset:0
  ds_read_b64_tr_b16 v[74:75], v118 offset:1024
  ds_read_b128 v[88:91], v114 offset:0
  ds_read_b128 v[104:107], v114 offset:8192
  v_mfma_f32_32x32x16_bf16 v[48:63], v[64:67], v[96:99], v[48:63]
  v_lshlrev_b32 v25, 2, v25
  v_xor_b32 v25, v25, v22
  v_lshl_add_u32 v19, v25, 3, v24
  s_waitcnt lgkmcnt(4)
  v_mfma_f32_32x32x16_bf16 v[32:47], v[68:71], v[84:87], v[32:47]
  ds_read_b64_tr_b16 v[76:77], v119 offset:0
  ds_read_b64_tr_b16 v[78:79], v119 offset:1024
  ds_read_b128 v[92:95], v115 offset:0
  ds_read_b128 v[108:111], v115 offset:8192
  v_mfma_f32_32x32x16_bf16 v[48:63], v[68:71], v[100:103], v[48:63]
  s_waitcnt vmcnt(4)
  s_barrier
  s_waitcnt lgkmcnt(4)
  v_mfma_f32_32x32x16_bf16 v[32:47], v[72:75], v[88:91], v[32:47]
  ds_read_b64_tr_b16 v[64:65], v116 offset:32768
  ds_read_b64_tr_b16 v[66:67], v116 offset:33792
  ds_read_b128 v[80:83], v112 offset:32768
  ds_read_b128 v[96:99], v112 offset:40960
  s_lshl_b32 s100, s75, 7
  s_add_u32 s100, s100, s62
  s_add_u32 m0, s64, 32768
  s_nop 0
  buffer_load_dwordx4 v3, s[24:27], s100 offen lds
  v_mfma_f32_32x32x16_bf16 v[48:63], v[72:75], v[104:107], v[48:63]
  s_lshl_b32 s100, s75, 7
  s_add_u32 s100, s100, s62
  s_add_u32 s100, s100, 1310720
  s_add_u32 m0, s64, 40960
  s_nop 0
  buffer_load_dwordx4 v3, s[24:27], s100 offen lds
  s_waitcnt lgkmcnt(4)
  v_mfma_f32_32x32x16_bf16 v[32:47], v[76:79], v[92:95], v[32:47]
  ds_read_b64_tr_b16 v[68:69], v117 offset:32768
  ds_read_b64_tr_b16 v[70:71], v117 offset:33792
  ds_read_b128 v[84:87], v113 offset:32768
  ds_read_b128 v[100:103], v113 offset:40960
  s_mul_i32 s100, s75, 245760
  s_add_u32 s100, s100, s63
  s_add_u32 m0, s65, 32768
  s_nop 0
  buffer_load_dwordx4 v4, s[28:31], s100 offen lds
  v_mfma_f32_32x32x16_bf16 v[48:63], v[76:79], v[108:111], v[48:63]
  s_mul_i32 s100, s75, 245760
  s_add_u32 s100, s100, s63
  s_add_u32 s100, s100, 15360
  s_add_u32 m0, s65, 33792
  s_nop 0
  buffer_load_dwordx4 v4, s[28:31], s100 offen lds
  s_waitcnt lgkmcnt(4)
  v_mfma_f32_32x32x16_bf16 v[32:47], v[64:67], v[80:83], v[32:47]
  ds_read_b64_tr_b16 v[72:73], v118 offset:32768
  ds_read_b64_tr_b16 v[74:75], v118 offset:33792
  ds_read_b128 v[88:91], v114 offset:32768
  ds_read_b128 v[104:107], v114 offset:40960
  v_mfma_f32_32x32x16_bf16 v[48:63], v[64:67], v[96:99], v[48:63]
  s_waitcnt lgkmcnt(4)
  v_mfma_f32_32x32x16_bf16 v[32:47], v[68:71], v[84:87], v[32:47]
  ds_read_b64_tr_b16 v[76:77], v119 offset:32768
  ds_read_b64_tr_b16 v[78:79], v119 offset:33792
  ds_read_b128 v[92:95], v115 offset:32768
  ds_read_b128 v[108:111], v115 offset:40960
  v_mfma_f32_32x32x16_bf16 v[48:63], v[68:71], v[100:103], v[48:63]
  s_waitcnt vmcnt(4)
  s_barrier
  v_and_b32 v13, 31, v1
  v_lshlrev_b32 v13, 3, v13
  v_lshrrev_b32 v14, 5, v1
  v_mul_u32_u24 v14, 76800, v14
  v_add_u32 v13, v13, v14
  s_lshl_b32 s52, s56, 10
  s_add_u32 s52, s52, 34078720
  s_lshl_b32 s53, s59, 8
  s_add_u32 s52, s52, s53
  buffer_load_dwordx2 v[144:145], v13, s[32:35], s52 offen sc1
  s_add_u32 s52, s52, 15360
  buffer_load_dwordx2 v[146:147], v13, s[32:35], s52 offen sc1
  s_add_u32 s52, s52, 15360
  buffer_load_dwordx2 v[148:149], v13, s[32:35], s52 offen sc1
  s_add_u32 s52, s52, 15360
  buffer_load_dwordx2 v[150:151], v13, s[32:35], s52 offen sc1
  s_add_u32 s52, s52, 15360
  buffer_load_dwordx2 v[152:153], v13, s[32:35], s52 offen sc1
  s_add_u32 s52, s52, 15360
  v_and_b32 v13, 31, v1
  v_lshlrev_b32 v13, 4, v13
  v_lshrrev_b32 v14, 5, v1
  v_lshl_add_u32 v13, v14, 14, v13
  s_lshl_b32 s52, s57, 10
  s_lshl_b32 s53, s60, 9
  s_add_u32 s52, s52, s53
  s_add_u32 s52, s52, 34340864
  buffer_load_dwordx4 v[156:159], v13, s[32:35], s52 offen sc1
  s_min_u32 s55, s3, 6
  s_mul_i32 s52, s2, 7
  s_add_u32 s52, s52, s55
  s_add_u32 s52, s52, 0
  s_min_u32 s52, s52, 1639
  s_lshl_b32 s55, s3, 12
  s_add_u32 s55, s55, 131072
  s_mov_b32 s86, 0
  v_bfe_u32 v15, v1, 2, 2
  s_cmp_ge_u32 s52, 680
  s_nop 1
  s_cbranch_scc1 s0f4_23
  s_cmp_ge_u32 s52, 200
  s_cbranch_scc1 s0f5_24
  s_mov_b32 s89, 20
  s_mov_b32 s90, 25165824
  s_mul_i32 s87, s52, 6554
  s_lshr_b32 s87, s87, 16
  s_mul_i32 s88, s87, 10
  s_sub_u32 s88, s52, s88
  s_lshr_b32 s53, s87, 2
  s_add_u32 s53, s53, s87
  s_sub_u32 s54, s87, 16
  s_mul_i32 s54, s54, 5
  s_add_u32 s54, s54, 4
  s_cmp_ge_u32 s87, 16
  s_cselect_b32 s87, s54, s53
  s_branch s0fg_25
s0f5_24:
  s_sub_u32 s52, s52, 200
  s_mov_b32 s89, 48
  s_mov_b32 s90, 31457280
  s_mul_i32 s87, s52, 6554
  s_lshr_b32 s87, s87, 16
  s_mul_i32 s88, s87, 10
  s_sub_u32 s88, s52, s88
s0fg_25:
  v_lshrrev_b32 v14, 4, v1
  v_lshl_add_u32 v14, v14, 3, v15
  v_lshlrev_b32 v14, 7, v14
  v_and_b32 v15, 3, v1
  v_lshl_add_u32 v14, v15, 3, v14
  s_lshl_b32 s52, s88, 2
  s_add_u32 s52, s52, 0
  s_mul_i32 s53, s52, 52
  s_lshr_b32 s53, s53, 8
  s_mul_i32 s54, s53, 5
  s_sub_u32 s54, s52, s54
  s_mul_i32 s53, s53, s89
  s_add_u32 s53, s53, s87
  s_mul_i32 s53, s53, 5
  s_add_u32 s53, s53, s54
  s_lshl_b32 s53, s53, 10
  s_add_u32 s96, s53, s90
  s_lshl_b32 s52, s88, 2
  s_add_u32 s52, s52, 1
  s_mul_i32 s53, s52, 52
  s_lshr_b32 s53, s53, 8
  s_mul_i32 s54, s53, 5
  s_sub_u32 s54, s52, s54
  s_mul_i32 s53, s53, s89
  s_add_u32 s53, s53, s87
  s_mul_i32 s53, s53, 5
  s_add_u32 s53, s53, s54
  s_lshl_b32 s53, s53, 10
  s_add_u32 s97, s53, s90
  s_lshl_b32 s52, s88, 2
  s_add_u32 s52, s52, 2
  s_mul_i32 s53, s52, 52
  s_lshr_b32 s53, s53, 8
  s_mul_i32 s54, s53, 5
  s_sub_u32 s54, s52, s54
  s_mul_i32 s53, s53, s89
  s_add_u32 s53, s53, s87
  s_mul_i32 s53, s53, 5
  s_add_u32 s53, s53, s54
  s_lshl_b32 s53, s53, 10
  s_add_u32 s98, s53, s90
  s_lshl_b32 s52, s88, 2
  s_add_u32 s52, s52, 3
  s_mul_i32 s53, s52, 52
  s_lshr_b32 s53, s53, 8
  s_mul_i32 s54, s53, 5
  s_sub_u32 s54, s52, s54
  s_mul_i32 s53, s53, s89
  s_add_u32 s53, s53, s87
  s_mul_i32 s53, s53, 5
  s_add_u32 s53, s53, s54
  s_lshl_b32 s53, s53, 10
  s_add_u32 s99, s53, s90
  s_branch s0fs_26
s0f4_23:
  s_sub_u32 s52, s52, 680
  s_mul_i32 s87, s52, 2731
  s_lshr_b32 s87, s87, 16
  s_mul_i32 s88, s87, 24
  s_sub_u32 s88, s52, s88
  v_lshrrev_b32 v14, 5, v1
  v_lshl_add_u32 v14, v14, 3, v15
  v_lshlrev_b32 v14, 7, v14
  v_bfe_u32 v15, v1, 4, 1
  v_lshl_add_u32 v14, v15, 11, v14
  v_and_b32 v15, 1, v1
  v_lshl_add_u32 v14, v15, 4, v14
  v_bfe_u32 v15, v1, 1, 1
  v_lshl_add_u32 v14, v15, 3, v14
  s_lshl_b32 s52, s88, 2
  s_add_u32 s52, s52, 0
  s_mul_i32 s53, s52, 171
  s_lshr_b32 s53, s53, 9
  s_mul_i32 s54, s53, 3
  s_sub_u32 s54, s52, s54
  s_mul_i32 s53, s53, 40
  s_add_u32 s53, s53, s87
  s_mul_i32 s53, s53, 3
  s_add_u32 s53, s53, s54
  s_lshl_b32 s53, s53, 10
  s_add_u32 s96, s53, 27262976
  s_lshl_b32 s52, s88, 2
  s_add_u32 s52, s52, 1
  s_mul_i32 s53, s52, 171
  s_lshr_b32 s53, s53, 9
  s_mul_i32 s54, s53, 3
  s_sub_u32 s54, s52, s54
  s_mul_i32 s53, s53, 40
  s_add_u32 s53, s53, s87
  s_mul_i32 s53, s53, 3
  s_add_u32 s53, s53, s54
  s_lshl_b32 s53, s53, 10
  s_add_u32 s97, s53, 27262976
  s_lshl_b32 s52, s88, 2
  s_add_u32 s52, s52, 2
  s_mul_i32 s53, s52, 171
  s_lshr_b32 s53, s53, 9
  s_mul_i32 s54, s53, 3
  s_sub_u32 s54, s52, s54
  s_mul_i32 s53, s53, 40
  s_add_u32 s53, s53, s87
  s_mul_i32 s53, s53, 3
  s_add_u32 s53, s53, s54
  s_lshl_b32 s53, s53, 10
  s_add_u32 s98, s53, 27262976
  s_lshl_b32 s52, s88, 2
  s_add_u32 s52, s52, 3
  s_mul_i32 s53, s52, 171
  s_lshr_b32 s53, s53, 9
  s_mul_i32 s54, s53, 3
  s_sub_u32 s54, s52, s54
  s_mul_i32 s53, s53, 40
  s_add_u32 s53, s53, s87
  s_mul_i32 s53, s53, 3
  s_add_u32 s53, s53, s54
  s_lshl_b32 s53, s53, 10
  s_add_u32 s99, s53, 27262976
  s_mov_b32 s86, 1
s0fs_26:
  v_add_u32 v14, s55, v14
  ds_read_b64_tr_b16 v[224:225], v14 offset:0
  ds_read_b64_tr_b16 v[226:227], v14 offset:512
  ds_read_b64_tr_b16 v[228:229], v14 offset:32
  ds_read_b64_tr_b16 v[230:231], v14 offset:544
  ds_read_b64_tr_b16 v[232:233], v14 offset:64
  ds_read_b64_tr_b16 v[234:235], v14 offset:576
  ds_read_b64_tr_b16 v[236:237], v14 offset:96
  ds_read_b64_tr_b16 v[238:239], v14 offset:608
  s_waitcnt lgkmcnt(0)
  buffer_store_dwordx4 v[224:227], v2, s[32:35], s96 offen sc1
  buffer_store_dwordx4 v[228:231], v2, s[32:35], s97 offen sc1
  buffer_store_dwordx4 v[232:235], v2, s[32:35], s98 offen sc1
  buffer_store_dwordx4 v[236:239], v2, s[32:35], s99 offen sc1
  s_cmp_eq_u32 s86, 0
  s_nop 0
  s_cbranch_scc1 s0f_22
  v_mov_b32 v240, 0
  v_mov_b32 v241, 0
  v_mov_b32 v242, 0
  v_mov_b32 v243, 0
  v_dot2c_f32_bf16 v240, s94, v224
  v_dot2c_f32_bf16 v241, s94, v228
  v_dot2c_f32_bf16 v242, s94, v232
  v_dot2c_f32_bf16 v243, s94, v236
  v_dot2c_f32_bf16 v240, s94, v225
  v_dot2c_f32_bf16 v241, s94, v229
  v_dot2c_f32_bf16 v242, s94, v233
  v_dot2c_f32_bf16 v243, s94, v237
  v_dot2c_f32_bf16 v240, s94, v226
  v_dot2c_f32_bf16 v241, s94, v230
  v_dot2c_f32_bf16 v242, s94, v234
  v_dot2c_f32_bf16 v243, s94, v238
  v_dot2c_f32_bf16 v240, s94, v227
  v_dot2c_f32_bf16 v241, s94, v231
  v_dot2c_f32_bf16 v242, s94, v235
  v_dot2c_f32_bf16 v243, s94, v239
  s_nop 0
  v_permlane32_swap_b32 v240, v241
  v_add_f32 v240, v240, v241
  v_permlane32_swap_b32 v242, v243
  v_add_f32 v242, v242, v243
  v_lshlrev_b32 v14, 2, v1
  s_lshl_b32 s52, s88, 9
  s_mul_i32 s53, s87, 12288
  s_add_u32 s52, s52, s53
  s_add_u32 s52, s52, 24641536
  buffer_store_dword v240, v14, s[32:35], s52 offen offset:0 sc1
  buffer_store_dword v242, v14, s[32:35], s52 offen offset:256 sc1
s0f_22:
  s_waitcnt lgkmcnt(4)
  v_mfma_f32_32x32x16_bf16 v[32:47], v[72:75], v[88:91], v[32:47]
  ds_read_b64_tr_b16 v[64:65], v9 offset:0
  ds_read_b64_tr_b16 v[66:67], v9 offset:1024
  ds_read_b128 v[80:83], v5 offset:0
  ds_read_b128 v[96:99], v5 offset:8192
  v_mfma_f32_32x32x16_bf16 v[48:63], v[72:75], v[104:107], v[48:63]
  s_waitcnt lgkmcnt(4)
  v_mfma_f32_32x32x16_bf16 v[32:47], v[76:79], v[92:95], v[32:47]
  ds_read_b64_tr_b16 v[68:69], v10 offset:0
  ds_read_b64_tr_b16 v[70:71], v10 offset:1024
  ds_read_b128 v[84:87], v6 offset:0
  ds_read_b128 v[100:103], v6 offset:8192
  v_mfma_f32_32x32x16_bf16 v[48:63], v[76:79], v[108:111], v[48:63]
  s_waitcnt lgkmcnt(4)
  v_mfma_f32_32x32x16_bf16 v[32:47], v[64:67], v[80:83], v[32:47]
  ds_read_b64_tr_b16 v[72:73], v11 offset:0
  ds_read_b64_tr_b16 v[74:75], v11 offset:1024
  ds_read_b128 v[88:91], v7 offset:0
  ds_read_b128 v[104:107], v7 offset:8192
  v_mfma_f32_32x32x16_bf16 v[48:63], v[64:67], v[96:99], v[48:63]
  s_waitcnt lgkmcnt(4)
  v_mfma_f32_32x32x16_bf16 v[32:47], v[68:71], v[84:87], v[32:47]
  ds_read_b64_tr_b16 v[76:77], v12 offset:0
  ds_read_b64_tr_b16 v[78:79], v12 offset:1024
  ds_read_b128 v[92:95], v8 offset:0
  ds_read_b128 v[108:111], v8 offset:8192
  v_mfma_f32_32x32x16_bf16 v[48:63], v[68:71], v[100:103], v[48:63]
  s_waitcnt vmcnt(10)
  s_barrier
  s_waitcnt lgkmcnt(4)
  v_mfma_f32_32x32x16_bf16 v[32:47], v[72:75], v[88:91], v[32:47]
  ds_read_b64_tr_b16 v[64:65], v9 offset:32768
  ds_read_b64_tr_b16 v[66:67], v9 offset:33792
  ds_read_b128 v[80:83], v5 offset:32768
  ds_read_b128 v[96:99], v5 offset:40960
  v_mfma_f32_32x32x16_bf16 v[48:63], v[72:75], v[104:107], v[48:63]
  s_waitcnt lgkmcnt(4)
  v_mfma_f32_32x32x16_bf16 v[32:47], v[76:79], v[92:95], v[32:47]
  ds_read_b64_tr_b16 v[68:69], v10 offset:32768
  ds_read_b64_tr_b16 v[70:71], v10 offset:33792
  ds_read_b128 v[84:87], v6 offset:32768
  ds_read_b128 v[100:103], v6 offset:40960
  v_mfma_f32_32x32x16_bf16 v[48:63], v[76:79], v[108:111], v[48:63]
  s_waitcnt lgkmcnt(4)
  v_mfma_f32_32x32x16_bf16 v[32:47], v[64:67], v[80:83], v[32:47]
  ds_read_b64_tr_b16 v[72:73], v11 offset:32768
  ds_read_b64_tr_b16 v[74:75], v11 offset:33792
  ds_read_b128 v[88:91], v7 offset:32768
  ds_read_b128 v[104:107], v7 offset:40960
  v_mfma_f32_32x32x16_bf16 v[48:63], v[64:67], v[96:99], v[48:63]
  s_waitcnt lgkmcnt(4)
  v_mfma_f32_32x32x16_bf16 v[32:47], v[68:71], v[84:87], v[32:47]
  ds_read_b64_tr_b16 v[76:77], v12 offset:32768
  ds_read_b64_tr_b16 v[78:79], v12 offset:33792
  ds_read_b128 v[92:95], v8 offset:32768
  ds_read_b128 v[108:111], v8 offset:40960
  v_mfma_f32_32x32x16_bf16 v[48:63], v[68:71], v[100:103], v[48:63]
  s_waitcnt lgkmcnt(4)
  v_mfma_f32_32x32x16_bf16 v[32:47], v[72:75], v[88:91], v[32:47]
  v_mfma_f32_32x32x16_bf16 v[48:63], v[72:75], v[104:107], v[48:63]
  s_waitcnt lgkmcnt(0)
  v_mfma_f32_32x32x16_bf16 v[32:47], v[76:79], v[92:95], v[32:47]
  v_mfma_f32_32x32x16_bf16 v[48:63], v[76:79], v[108:111], v[48:63]
  s_waitcnt vmcnt(4)
  s_nop 10
  s_branch s1J_2
s1G1_1:
  s_waitcnt vmcnt(8)
  s_barrier
  ds_read_b64_tr_b16 v[64:65], v9 offset:0
  ds_read_b64_tr_b16 v[66:67], v9 offset:1024
  ds_read_b128 v[80:83], v5 offset:0
  ds_read_b128 v[96:99], v5 offset:8192
  ds_read_b64_tr_b16 v[68:69], v10 offset:0
  ds_read_b64_tr_b16 v[70:71], v10 offset:1024
  ds_read_b128 v[84:87], v6 offset:0
  ds_read_b128 v[100:103], v6 offset:8192
  s_waitcnt lgkmcnt(4)
  v_mfma_f32_32x32x16_bf16 v[32:47], v[64:67], v[80:83], 0
  ds_read_b64_tr_b16 v[72:73], v11 offset:0
  ds_read_b64_tr_b16 v[74:75], v11 offset:1024
  ds_read_b128 v[88:91], v7 offset:0
  ds_read_b128 v[104:107], v7 offset:8192
  v_mfma_f32_32x32x16_bf16 v[48:63], v[64:67], v[96:99], 0
  s_waitcnt lgkmcnt(4)
  v_mfma_f32_32x32x16_bf16 v[32:47], v[68:71], v[84:87], v[32:47]
  ds_read_b64_tr_b16 v[76:77], v12 offset:0
  ds_read_b64_tr_b16 v[78:79], v12 offset:1024
  ds_read_b128 v[92:95], v8 offset:0
  ds_read_b128 v[108:111], v8 offset:8192
  s_lshl_b32 s100, s69, 7
  s_add_u32 s100, s100, s62
  s_add_u32 m0, s64, 98304
  s_nop 0
  buffer_load_dwordx4 v3, s[24:27], s100 offen lds
  v_mfma_f32_32x32x16_bf16 v[48:63], v[68:71], v[100:103], v[48:63]
  s_lshl_b32 s100, s69, 7
  s_add_u32 s100, s100, s62
  s_add_u32 s100, s100, 1310720
  s_add_u32 m0, s64, 106496
  s_nop 0
  buffer_load_dwordx4 v3, s[24:27], s100 offen lds
  s_waitcnt vmcnt(6)
  s_barrier
  s_waitcnt lgkmcnt(4)
  v_mfma_f32_32x32x16_bf16 v[32:47], v[72:75], v[88:91], v[32:47]
  ds_read_b64_tr_b16 v[64:65], v9 offset:32768
  ds_read_b64_tr_b16 v[66:67], v9 offset:33792
  ds_read_b128 v[80:83], v5 offset:32768
  ds_read_b128 v[96:99], v5 offset:40960
  s_mul_i32 s100, s69, 245760
  s_add_u32 s100, s100, s63
  s_add_u32 m0, s65, 98304
  s_nop 0
  buffer_load_dwordx4 v4, s[28:31], s100 offen lds
  v_mfma_f32_32x32x16_bf16 v[48:63], v[72:75], v[104:107], v[48:63]
  s_mul_i32 s100, s69, 245760
  s_add_u32 s100, s100, s63
  s_add_u32 s100, s100, 15360
  s_add_u32 m0, s65, 99328
  s_nop 0
  buffer_load_dwordx4 v4, s[28:31], s100 offen lds
  s_waitcnt lgkmcnt(4)
  v_mfma_f32_32x32x16_bf16 v[32:47], v[76:79], v[92:95], v[32:47]
  ds_read_b64_tr_b16 v[68:69], v10 offset:32768
  ds_read_b64_tr_b16 v[70:71], v10 offset:33792
  ds_read_b128 v[84:87], v6 offset:32768
  ds_read_b128 v[100:103], v6 offset:40960
  buffer_load_dword v124, off, s[48:51], 0 sc1
  v_mfma_f32_32x32x16_bf16 v[48:63], v[76:79], v[108:111], v[48:63]
  s_waitcnt lgkmcnt(4)
  v_mfma_f32_32x32x16_bf16 v[32:47], v[64:67], v[80:83], v[32:47]
  ds_read_b64_tr_b16 v[72:73], v11 offset:32768
  ds_read_b64_tr_b16 v[74:75], v11 offset:33792
  ds_read_b128 v[88:91], v7 offset:32768
  ds_read_b128 v[104:107], v7 offset:40960
  v_mfma_f32_32x32x16_bf16 v[48:63], v[64:67], v[96:99], v[48:63]
  s_waitcnt lgkmcnt(4)
  v_mfma_f32_32x32x16_bf16 v[32:47], v[68:71], v[84:87], v[32:47]
  ds_read_b64_tr_b16 v[76:77], v12 offset:32768
  ds_read_b64_tr_b16 v[78:79], v12 offset:33792
  ds_read_b128 v[92:95], v8 offset:32768
  ds_read_b128 v[108:111], v8 offset:40960
  v_mfma_f32_32x32x16_bf16 v[48:63], v[68:71], v[100:103], v[48:63]
  s_waitcnt vmcnt(5)
  s_barrier
  s_waitcnt lgkmcnt(4)
  v_mfma_f32_32x32x16_bf16 v[32:47], v[72:75], v[88:91], v[32:47]
  ds_read_b64_tr_b16 v[64:65], v116 offset:0
  ds_read_b64_tr_b16 v[66:67], v116 offset:1024
  ds_read_b128 v[80:83], v112 offset:0
  ds_read_b128 v[96:99], v112 offset:8192
  v_mfma_f32_32x32x16_bf16 v[48:63], v[72:75], v[104:107], v[48:63]
  s_waitcnt lgkmcnt(4)
  v_mfma_f32_32x32x16_bf16 v[32:47], v[76:79], v[92:95], v[32:47]
  ds_read_b64_tr_b16 v[68:69], v117 offset:0
  ds_read_b64_tr_b16 v[70:71], v117 offset:1024
  ds_read_b128 v[84:87], v113 offset:0
  ds_read_b128 v[100:103], v113 offset:8192
  v_mfma_f32_32x32x16_bf16 v[48:63], v[76:79], v[108:111], v[48:63]
  s_waitcnt lgkmcnt(4)
  v_mfma_f32_32x32x16_bf16 v[32:47], v[64:67], v[80:83], v[32:47]
  ds_read_b64_tr_b16 v[72:73], v118 offset:0
  ds_read_b64_tr_b16 v[74:75], v118 offset:1024
  ds_read_b128 v[88:91], v114 offset:0
  ds_read_b128 v[104:107], v114 offset:8192
  s_lshl_b32 s100, s70, 7
  s_add_u32 s100, s100, s62
  s_add_u32 m0, s64, 0
  s_nop 0
  buffer_load_dwordx4 v3, s[24:27], s100 offen lds
  v_mfma_f32_32x32x16_bf16 v[48:63], v[64:67], v[96:99], v[48:63]
  s_lshl_b32 s100, s70, 7
  s_add_u32 s100, s100, s62
  s_add_u32 s100, s100, 1310720
  s_add_u32 m0, s64, 8192
  s_nop 0
  buffer_load_dwordx4 v3, s[24:27], s100 offen lds
  s_waitcnt lgkmcnt(4)
  v_mfma_f32_32x32x16_bf16 v[32:47], v[68:71], v[84:87], v[32:47]
  ds_read_b64_tr_b16 v[76:77], v119 offset:0
  ds_read_b64_tr_b16 v[78:79], v119 offset:1024
  ds_read_b128 v[92:95], v115 offset:0
  ds_read_b128 v[108:111], v115 offset:8192
  s_mul_i32 s100, s70, 245760
  s_add_u32 s100, s100, s63
  s_add_u32 m0, s65, 0
  s_nop 0
  buffer_load_dwordx4 v4, s[28:31], s100 offen lds
  v_mfma_f32_32x32x16_bf16 v[48:63], v[68:71], v[100:103], v[48:63]
  s_mul_i32 s100, s70, 245760
  s_add_u32 s100, s100, s63
  s_add_u32 s100, s100, 15360
  s_add_u32 m0, s65, 1024
  s_nop 0
  buffer_load_dwordx4 v4, s[28:31], s100 offen lds
  s_waitcnt vmcnt(5)
  s_waitcnt vmcnt(4)
  s_nop 3
nchk_27:
  v_readfirstlane_b32 s92, v124
  s_nop 1
  s_cmp_lg_u32 s92, 0
  s_nop 1
  s_cbranch_scc1 nok_28
  s_add_u32 s95, s95, 1
  s_cmp_gt_u32 s95, 20000
  s_cbranch_scc1 nok_28
  s_sleep 8
  s_waitcnt vmcnt(0) lgkmcnt(0)
  buffer_load_dword v124, off, s[48:51], 0 sc1
  s_waitcnt vmcnt(0)
  s_branch nchk_27
nok_28:
  s_barrier
  s_min_u32 s55, s3, 6
  s_mul_i32 s52, s2, 7
  s_add_u32 s52, s52, s55
  s_add_u32 s52, s52, 0
  s_min_u32 s52, s52, 1639
  s_lshl_b32 s55, s3, 12
  s_add_u32 s55, s55, 131072
  v_lshrrev_b32 v14, 3, v1
  v_and_b32 v15, 7, v1
  s_cmp_ge_u32 s52, 680
  s_nop 1
  s_cbranch_scc1 s0i4_30
  s_cmp_ge_u32 s52, 200
  s_cbranch_scc1 s0i5_31
  s_mov_b32 s40, s8
  s_and_b32 s41, s9, 0xffff
  s_mov_b32 s42, 819200
  s_mov_b32 s43, 0x20000
  s_mul_i32 s87, s52, 6554
  s_lshr_b32 s87, s87, 16
  s_mul_i32 s88, s87, 10
  s_sub_u32 s88, s52, s88
  s_lshl_b32 s54, s88, 7
  s_cmp_ge_u32 s87, 16
  s_cbranch_scc1 s0ig_32
  s_mul_i32 s53, s87, 51200
  s_add_u32 s53, s53, s54
  v_mul_u32_u24 v14, 1280, v14
  v_lshl_add_u32 v14, v15, 4, v14
  s_add_u32 m0, s55, 0
  s_add_u32 s54, s53, 0
  buffer_load_dwordx4 v14, s[40:43], s54 offen lds
  s_add_u32 m0, s55, 1024
  s_add_u32 s54, s53, 10240
  buffer_load_dwordx4 v14, s[40:43], s54 offen lds
  s_add_u32 m0, s55, 2048
  s_add_u32 s54, s53, 25600
  buffer_load_dwordx4 v14, s[40:43], s54 offen lds
  s_add_u32 m0, s55, 3072
  s_add_u32 s54, s53, 35840
  buffer_load_dwordx4 v14, s[40:43], s54 offen lds
  s_branch s0i_29
s0ig_32:
  s_sub_u32 s53, s87, 16
  s_mul_i32 s53, s53, 204800
  s_add_u32 s53, s53, s54
  s_add_u32 s53, s53, 20480
  v_lshlrev_b32 v15, 4, v15
  v_and_b32 v14, 3, v14
  v_mul_u32_u24 v14, 1280, v14
  v_add_u32 v15, v15, v14
  v_lshrrev_b32 v14, 5, v1
  v_mul_u32_u24 v14, 25600, v14
  v_add_u32 v14, v14, v15
  s_add_u32 m0, s55, 0
  s_nop 0
  buffer_load_dwordx4 v14, s[40:43], s53 offen lds
  s_add_u32 s53, s53, 51200
  s_add_u32 m0, s55, 1024
  s_nop 0
  buffer_load_dwordx4 v14, s[40:43], s53 offen lds
  s_add_u32 s53, s53, 51200
  s_add_u32 m0, s55, 2048
  s_nop 0
  buffer_load_dwordx4 v14, s[40:43], s53 offen lds
  s_add_u32 s53, s53, 51200
  s_add_u32 m0, s55, 3072
  s_nop 0
  buffer_load_dwordx4 v14, s[40:43], s53 offen lds
  s_branch s0i_29
s0i5_31:
  s_mov_b32 s40, s16
  s_and_b32 s41, s17, 0xffff
  s_mov_b32 s42, 1966080
  s_mov_b32 s43, 0x20000
  s_sub_u32 s52, s52, 200
  s_mul_i32 s87, s52, 6554
  s_lshr_b32 s87, s87, 16
  s_mul_i32 s88, s87, 10
  s_sub_u32 s88, s52, s88
  s_mul_i32 s53, s87, 40960
  s_lshl_b32 s54, s88, 7
  s_add_u32 s53, s53, s54
  v_mul_u32_u24 v14, 1280, v14
  v_lshl_add_u32 v14, v15, 4, v14
  s_add_u32 m0, s55, 0
  s_nop 0
  buffer_load_dwordx4 v14, s[40:43], s53 offen lds
  s_add_u32 s53, s53, 10240
  s_add_u32 m0, s55, 1024
  s_nop 0
  buffer_load_dwordx4 v14, s[40:43], s53 offen lds
  s_add_u32 s53, s53, 10240
  s_add_u32 m0, s55, 2048
  s_nop 0
  buffer_load_dwordx4 v14, s[40:43], s53 offen lds
  s_add_u32 s53, s53, 10240
  s_add_u32 m0, s55, 3072
  s_nop 0
  buffer_load_dwordx4 v14, s[40:43], s53 offen lds
  s_branch s0i_29
s0i4_30:
  s_sub_u32 s52, s52, 680
  s_mul_i32 s87, s52, 2731
  s_lshr_b32 s87, s87, 16
  s_mul_i32 s88, s87, 24
  s_sub_u32 s88, s52, s88
  s_mul_i32 s53, s87, 49152
  s_lshl_b32 s54, s88, 7
  s_add_u32 s53, s53, s54
  s_add_u32 s54, s53, 24576
  v_mul_u32_u24 v14, 3072, v14
  v_lshl_add_u32 v14, v15, 4, v14
  s_mov_b32 s40, s12
  s_and_b32 s41, s13, 0xffff
  s_mov_b32 s42, 1966080
  s_mov_b32 s43, 0x20000
  s_add_u32 m0, s55, 0
  s_nop 0
  buffer_load_dwordx4 v14, s[40:43], s53 offen lds
  s_add_u32 m0, s55, 1024
  s_nop 0
  buffer_load_dwordx4 v14, s[40:43], s54 offen lds
  s_mov_b32 s40, s14
  s_and_b32 s41, s15, 0xffff
  s_mov_b32 s42, 1966080
  s_mov_b32 s43, 0x20000
  s_add_u32 m0, s55, 2048
  s_nop 0
  buffer_load_dwordx4 v14, s[40:43], s53 offen lds
  s_add_u32 m0, s55, 3072
  s_nop 0
  buffer_load_dwordx4 v14, s[40:43], s54 offen lds
s0i_29:
  s_waitcnt lgkmcnt(4)
  v_mfma_f32_32x32x16_bf16 v[32:47], v[72:75], v[88:91], v[32:47]
  ds_read_b64_tr_b16 v[64:65], v116 offset:32768
  ds_read_b64_tr_b16 v[66:67], v116 offset:33792
  ds_read_b128 v[80:83], v112 offset:32768
  ds_read_b128 v[96:99], v112 offset:40960
  v_mfma_f32_32x32x16_bf16 v[48:63], v[72:75], v[104:107], v[48:63]
  s_waitcnt lgkmcnt(4)
  v_mfma_f32_32x32x16_bf16 v[32:47], v[76:79], v[92:95], v[32:47]
  ds_read_b64_tr_b16 v[68:69], v117 offset:32768
  ds_read_b64_tr_b16 v[70:71], v117 offset:33792
  ds_read_b128 v[84:87], v113 offset:32768
  ds_read_b128 v[100:103], v113 offset:40960
  v_mfma_f32_32x32x16_bf16 v[48:63], v[76:79], v[108:111], v[48:63]
  s_waitcnt lgkmcnt(4)
  v_mfma_f32_32x32x16_bf16 v[32:47], v[64:67], v[80:83], v[32:47]
  ds_read_b64_tr_b16 v[72:73], v118 offset:32768
  ds_read_b64_tr_b16 v[74:75], v118 offset:33792
  ds_read_b128 v[88:91], v114 offset:32768
  ds_read_b128 v[104:107], v114 offset:40960
  s_lshl_b32 s100, s71, 7
  s_add_u32 s100, s100, s62
  s_add_u32 m0, s64, 32768
  s_nop 0
  buffer_load_dwordx4 v3, s[24:27], s100 offen lds
  v_mfma_f32_32x32x16_bf16 v[48:63], v[64:67], v[96:99], v[48:63]
  s_lshl_b32 s100, s71, 7
  s_add_u32 s100, s100, s62
  s_add_u32 s100, s100, 1310720
  s_add_u32 m0, s64, 40960
  s_nop 0
  buffer_load_dwordx4 v3, s[24:27], s100 offen lds
  s_waitcnt lgkmcnt(4)
  v_mfma_f32_32x32x16_bf16 v[32:47], v[68:71], v[84:87], v[32:47]
  ds_read_b64_tr_b16 v[76:77], v119 offset:32768
  ds_read_b64_tr_b16 v[78:79], v119 offset:33792
  ds_read_b128 v[92:95], v115 offset:32768
  ds_read_b128 v[108:111], v115 offset:40960
  s_mul_i32 s100, s71, 245760
  s_add_u32 s100, s100, s63
  s_add_u32 m0, s65, 32768
  s_nop 0
  buffer_load_dwordx4 v4, s[28:31], s100 offen lds
  v_mfma_f32_32x32x16_bf16 v[48:63], v[68:71], v[100:103], v[48:63]
  s_mul_i32 s100, s71, 245760
  s_add_u32 s100, s100, s63
  s_add_u32 s100, s100, 15360
  s_add_u32 m0, s65, 33792
  s_nop 0
  buffer_load_dwordx4 v4, s[28:31], s100 offen lds
  s_waitcnt vmcnt(8)
  s_barrier
  s_waitcnt lgkmcnt(4)
  v_mfma_f32_32x32x16_bf16 v[32:47], v[72:75], v[88:91], v[32:47]
  ds_read_b64_tr_b16 v[64:65], v9 offset:0
  ds_read_b64_tr_b16 v[66:67], v9 offset:1024
  ds_read_b128 v[80:83], v5 offset:0
  ds_read_b128 v[96:99], v5 offset:8192
  v_mfma_f32_32x32x16_bf16 v[48:63], v[72:75], v[104:107], v[48:63]
  s_waitcnt lgkmcnt(4)
  v_mfma_f32_32x32x16_bf16 v[32:47], v[76:79], v[92:95], v[32:47]
  ds_read_b64_tr_b16 v[68:69], v10 offset:0
  ds_read_b64_tr_b16 v[70:71], v10 offset:1024
  ds_read_b128 v[84:87], v6 offset:0
  ds_read_b128 v[100:103], v6 offset:8192
  v_mfma_f32_32x32x16_bf16 v[48:63], v[76:79], v[108:111], v[48:63]
  s_waitcnt lgkmcnt(4)
  v_mfma_f32_32x32x16_bf16 v[32:47], v[64:67], v[80:83], v[32:47]
  v_lshrrev_b32 v20, 5, v1
  v_add_u32 v20, s78, v20
  v_bfe_u32 v21, v1, 4, 1
  ds_read_b64_tr_b16 v[72:73], v11 offset:0
  ds_read_b64_tr_b16 v[74:75], v11 offset:1024
  ds_read_b128 v[88:91], v7 offset:0
  ds_read_b128 v[104:107], v7 offset:8192
  s_lshl_b32 s100, s72, 7
  s_add_u32 s100, s100, s62
  s_add_u32 m0, s64, 65536
  s_nop 0
  buffer_load_dwordx4 v3, s[24:27], s100 offen lds
  v_mfma_f32_32x32x16_bf16 v[48:63], v[64:67], v[96:99], v[48:63]
  v_add_u32 v21, s79, v21
  v_mul_u32_u24 v21, 640, v21
  v_and_b32 v22, 15, v1
  s_lshl_b32 s100, s72, 7
  s_add_u32 s100, s100, s62
  s_add_u32 s100, s100, 1310720
  s_add_u32 m0, s64, 73728
  s_nop 0
  buffer_load_dwordx4 v3, s[24:27], s100 offen lds
  s_waitcnt lgkmcnt(4)
  v_mfma_f32_32x32x16_bf16 v[32:47], v[68:71], v[84:87], v[32:47]
  v_add_u32 v23, 0, v20
  v_mul_u32_u24 v24, 0xcccd, v23
  v_lshrrev_b32 v24, 18, v24
  ds_read_b64_tr_b16 v[76:77], v12 offset:0
  ds_read_b64_tr_b16 v[78:79], v12 offset:1024
  ds_read_b128 v[92:95], v8 offset:0
  ds_read_b128 v[108:111], v8 offset:8192
  s_mul_i32 s100, s72, 245760
  s_add_u32 s100, s100, s63
  s_add_u32 m0, s65, 65536
  s_nop 0
  buffer_load_dwordx4 v4, s[28:31], s100 offen lds
  v_mfma_f32_32x32x16_bf16 v[48:63], v[68:71], v[100:103], v[48:63]
  v_mul_u32_u24 v25, 5, v24
  v_sub_u32 v25, v23, v25
  v_mul_lo_u32 v24, v24, s80
  s_mul_i32 s100, s72, 245760
  s_add_u32 s100, s100, s63
  s_add_u32 s100, s100, 15360
  s_add_u32 m0, s65, 66560
  s_nop 0
  buffer_load_dwordx4 v4, s[28:31], s100 offen lds
  s_waitcnt vmcnt(4)
  s_barrier
  s_waitcnt lgkmcnt(4)
  v_mfma_f32_32x32x16_bf16 v[32:47], v[72:75], v[88:91], v[32:47]
  v_add_u32 v24, v24, v21
  v_lshl_add_u32 v24, v25, 7, v24
  v_and_b32 v25, 2, v25
  ds_read_b64_tr_b16 v[64:65], v9 offset:32768
  ds_read_b64_tr_b16 v[66:67], v9 offset:33792
  ds_read_b128 v[80:83], v5 offset:32768
  ds_read_b128 v[96:99], v5 offset:40960
  v_mfma_f32_32x32x16_bf16 v[48:63], v[72:75], v[104:107], v[48:63]
  v_lshlrev_b32 v25, 2, v25
  v_xor_b32 v25, v25, v22
  v_lshl_add_u32 v16, v25, 3, v24
  s_waitcnt lgkmcnt(4)
  v_mfma_f32_32x32x16_bf16 v[32:47], v[76:79], v[92:95], v[32:47]
  v_add_u32 v23, 2, v20
  v_mul_u32_u24 v24, 0xcccd, v23
  v_lshrrev_b32 v24, 18, v24
  ds_read_b64_tr_b16 v[68:69], v10 offset:32768
  ds_read_b64_tr_b16 v[70:71], v10 offset:33792
  ds_read_b128 v[84:87], v6 offset:32768
  ds_read_b128 v[100:103], v6 offset:40960
  v_mfma_f32_32x32x16_bf16 v[48:63], v[76:79], v[108:111], v[48:63]
  v_mul_u32_u24 v25, 5, v24
  v_sub_u32 v25, v23, v25
  v_mul_lo_u32 v24, v24, s80
  s_waitcnt lgkmcnt(4)
  v_mfma_f32_32x32x16_bf16 v[32:47], v[64:67], v[80:83], v[32:47]
  v_add_u32 v24, v24, v21
  v_lshl_add_u32 v24, v25, 7, v24
  v_and_b32 v25, 2, v25
  ds_read_b64_tr_b16 v[72:73], v11 offset:32768
  ds_read_b64_tr_b16 v[74:75], v11 offset:33792
  ds_read_b128 v[88:91], v7 offset:32768
  ds_read_b128 v[104:107], v7 offset:40960
  s_lshl_b32 s100, s73, 7
  s_add_u32 s100, s100, s62
  s_add_u32 m0, s64, 98304
  s_nop 0
  buffer_load_dwordx4 v3, s[24:27], s100 offen lds
  v_mfma_f32_32x32x16_bf16 v[48:63], v[64:67], v[96:99], v[48:63]
  v_lshlrev_b32 v25, 2, v25
  v_xor_b32 v25, v25, v22
  v_lshl_add_u32 v17, v25, 3, v24
  s_lshl_b32 s100, s73, 7
  s_add_u32 s100, s100, s62
  s_add_u32 s100, s100, 1310720
  s_add_u32 m0, s64, 106496
  s_nop 0
  buffer_load_dwordx4 v3, s[24:27], s100 offen lds
  s_waitcnt lgkmcnt(4)
  v_mfma_f32_32x32x16_bf16 v[32:47], v[68:71], v[84:87], v[32:47]
  v_add_u32 v23, 4, v20
  v_mul_u32_u24 v24, 0xcccd, v23
  v_lshrrev_b32 v24, 18, v24
  ds_read_b64_tr_b16 v[76:77], v12 offset:32768
  ds_read_b64_tr_b16 v[78:79], v12 offset:33792
  ds_read_b128 v[92:95], v8 offset:32768
  ds_read_b128 v[108:111], v8 offset:40960
  s_mul_i32 s100, s73, 245760
  s_add_u32 s100, s100, s63
  s_add_u32 m0, s65, 98304
  s_nop 0
  buffer_load_dwordx4 v4, s[28:31], s100 offen lds
  v_mfma_f32_32x32x16_bf16 v[48:63], v[68:71], v[100:103], v[48:63]
  v_mul_u32_u24 v25, 5, v24
  v_sub_u32 v25, v23, v25
  v_mul_lo_u32 v24, v24, s80
  s_mul_i32 s100, s73, 245760
  s_add_u32 s100, s100, s63
  s_add_u32 s100, s100, 15360
  s_add_u32 m0, s65, 99328
  s_nop 0
  buffer_load_dwordx4 v4, s[28:31], s100 offen lds
  s_waitcnt vmcnt(4)
  s_barrier
  s_waitcnt lgkmcnt(4)
  v_mfma_f32_32x32x16_bf16 v[32:47], v[72:75], v[88:91], v[32:47]
  v_add_u32 v24, v24, v21
  v_lshl_add_u32 v24, v25, 7, v24
  v_and_b32 v25, 2, v25
  ds_read_b64_tr_b16 v[64:65], v116 offset:0
  ds_read_b64_tr_b16 v[66:67], v116 offset:1024
  ds_read_b128 v[80:83], v112 offset:0
  ds_read_b128 v[96:99], v112 offset:8192
  v_mfma_f32_32x32x16_bf16 v[48:63], v[72:75], v[104:107], v[48:63]
  v_lshlrev_b32 v25, 2, v25
  v_xor_b32 v25, v25, v22
  v_lshl_add_u32 v18, v25, 3, v24
  s_waitcnt lgkmcnt(4)
  v_mfma_f32_32x32x16_bf16 v[32:47], v[76:79], v[92:95], v[32:47]
  v_add_u32 v23, 6, v20
  v_mul_u32_u24 v24, 0xcccd, v23
  v_lshrrev_b32 v24, 18, v24
  ds_read_b64_tr_b16 v[68:69], v117 offset:0
  ds_read_b64_tr_b16 v[70:71], v117 offset:1024
  ds_read_b128 v[84:87], v113 offset:0
  ds_read_b128 v[100:103], v113 offset:8192
  v_mfma_f32_32x32x16_bf16 v[48:63], v[76:79], v[108:111], v[48:63]
  v_mul_u32_u24 v25, 5, v24
  v_sub_u32 v25, v23, v25
  v_mul_lo_u32 v24, v24, s80
  s_waitcnt lgkmcnt(4)
  v_mfma_f32_32x32x16_bf16 v[32:47], v[64:67], v[80:83], v[32:47]
  v_add_u32 v24, v24, v21
  v_lshl_add_u32 v24, v25, 7, v24
  v_and_b32 v25, 2, v25
  ds_read_b64_tr_b16 v[72:73], v118 offset:0
  ds_read_b64_tr_b16 v[74:75], v118 offset:1024
  ds_read_b128 v[88:91], v114 offset:0
  ds_read_b128 v[104:107], v114 offset:8192
  s_lshl_b32 s100, s74, 7
  s_add_u32 s100, s100, s62
  s_add_u32 m0, s64, 0
  s_nop 0
  buffer_load_dwordx4 v3, s[24:27], s100 offen lds
  v_mfma_f32_32x32x16_bf16 v[48:63], v[64:67], v[96:99], v[48:63]
  v_lshlrev_b32 v25, 2, v25
  v_xor_b32 v25, v25, v22
  v_lshl_add_u32 v19, v25, 3, v24
  s_lshl_b32 s100, s74, 7
  s_add_u32 s100, s100, s62
  s_add_u32 s100, s100, 1310720
  s_add_u32 m0, s64, 8192
  s_nop 0
  buffer_load_dwordx4 v3, s[24:27], s100 offen lds
  s_waitcnt lgkmcnt(4)
  v_mfma_f32_32x32x16_bf16 v[32:47], v[68:71], v[84:87], v[32:47]
  ds_read_b64_tr_b16 v[76:77], v119 offset:0
  ds_read_b64_tr_b16 v[78:79], v119 offset:1024
  ds_read_b128 v[92:95], v115 offset:0
  ds_read_b128 v[108:111], v115 offset:8192
  s_mul_i32 s100, s74, 245760
  s_add_u32 s100, s100, s63
  s_add_u32 m0, s65, 0
  s_nop 0
  buffer_load_dwordx4 v4, s[28:31], s100 offen lds
  v_mfma_f32_32x32x16_bf16 v[48:63], v[68:71], v[100:103], v[48:63]
  s_mul_i32 s100, s74, 245760
  s_add_u32 s100, s100, s63
  s_add_u32 s100, s100, 15360
  s_add_u32 m0, s65, 1024
  s_nop 0
  buffer_load_dwordx4 v4, s[28:31], s100 offen lds
  s_waitcnt vmcnt(4)
  s_barrier
  s_waitcnt lgkmcnt(4)
  v_mfma_f32_32x32x16_bf16 v[32:47], v[72:75], v[88:91], v[32:47]
  ds_read_b64_tr_b16 v[64:65], v116 offset:32768
  ds_read_b64_tr_b16 v[66:67], v116 offset:33792
  ds_read_b128 v[80:83], v112 offset:32768
  ds_read_b128 v[96:99], v112 offset:40960
  v_mfma_f32_32x32x16_bf16 v[48:63], v[72:75], v[104:107], v[48:63]
  s_waitcnt lgkmcnt(4)
  v_mfma_f32_32x32x16_bf16 v[32:47], v[76:79], v[92:95], v[32:47]
  ds_read_b64_tr_b16 v[68:69], v117 offset:32768
  ds_read_b64_tr_b16 v[70:71], v117 offset:33792
  ds_read_b128 v[84:87], v113 offset:32768
  ds_read_b128 v[100:103], v113 offset:40960
  v_mfma_f32_32x32x16_bf16 v[48:63], v[76:79], v[108:111], v[48:63]
  s_waitcnt lgkmcnt(4)
  v_mfma_f32_32x32x16_bf16 v[32:47], v[64:67], v[80:83], v[32:47]
  ds_read_b64_tr_b16 v[72:73], v118 offset:32768
  ds_read_b64_tr_b16 v[74:75], v118 offset:33792
  ds_read_b128 v[88:91], v114 offset:32768
  ds_read_b128 v[104:107], v114 offset:40960
  s_lshl_b32 s100, s75, 7
  s_add_u32 s100, s100, s62
  s_add_u32 m0, s64, 32768
  s_nop 0
  buffer_load_dwordx4 v3, s[24:27], s100 offen lds
  v_mfma_f32_32x32x16_bf16 v[48:63], v[64:67], v[96:99], v[48:63]
  s_lshl_b32 s100, s75, 7
  s_add_u32 s100, s100, s62
  s_add_u32 s100, s100, 1310720
  s_add_u32 m0, s64, 40960
  s_nop 0
  buffer_load_dwordx4 v3, s[24:27], s100 offen lds
  s_waitcnt lgkmcnt(4)
  v_mfma_f32_32x32x16_bf16 v[32:47], v[68:71], v[84:87], v[32:47]
  ds_read_b64_tr_b16 v[76:77], v119 offset:32768
  ds_read_b64_tr_b16 v[78:79], v119 offset:33792
  ds_read_b128 v[92:95], v115 offset:32768
  ds_read_b128 v[108:111], v115 offset:40960
  s_mul_i32 s100, s75, 245760
  s_add_u32 s100, s100, s63
  s_add_u32 m0, s65, 32768
  s_nop 0
  buffer_load_dwordx4 v4, s[28:31], s100 offen lds
  v_mfma_f32_32x32x16_bf16 v[48:63], v[68:71], v[100:103], v[48:63]
  s_mul_i32 s100, s75, 245760
  s_add_u32 s100, s100, s63
  s_add_u32 s100, s100, 15360
  s_add_u32 m0, s65, 33792
  s_nop 0
  buffer_load_dwordx4 v4, s[28:31], s100 offen lds
  s_waitcnt vmcnt(4)
  s_barrier
  v_and_b32 v13, 31, v1
  v_lshlrev_b32 v13, 3, v13
  v_lshrrev_b32 v14, 5, v1
  v_mul_u32_u24 v14, 76800, v14
  v_add_u32 v13, v13, v14
  s_lshl_b32 s52, s56, 10
  s_add_u32 s52, s52, 34078720
  s_lshl_b32 s53, s59, 8
  s_add_u32 s52, s52, s53
  buffer_load_dwordx2 v[144:145], v13, s[32:35], s52 offen sc1
  s_add_u32 s52, s52, 15360
  buffer_load_dwordx2 v[146:147], v13, s[32:35], s52 offen sc1
  s_add_u32 s52, s52, 15360
  buffer_load_dwordx2 v[148:149], v13, s[32:35], s52 offen sc1
  s_add_u32 s52, s52, 15360
  buffer_load_dwordx2 v[150:151], v13, s[32:35], s52 offen sc1
  s_add_u32 s52, s52, 15360
  buffer_load_dwordx2 v[152:153], v13, s[32:35], s52 offen sc1
  s_add_u32 s52, s52, 15360
  v_and_b32 v13, 31, v1
  v_lshlrev_b32 v13, 4, v13
  v_lshrrev_b32 v14, 5, v1
  v_lshl_add_u32 v13, v14, 14, v13
  s_lshl_b32 s52, s57, 10
  s_lshl_b32 s53, s60, 9
  s_add_u32 s52, s52, s53
  s_add_u32 s52, s52, 34340864
  buffer_load_dwordx4 v[156:159], v13, s[32:35], s52 offen sc1
  s_waitcnt lgkmcnt(4)
  v_mfma_f32_32x32x16_bf16 v[32:47], v[72:75], v[88:91], v[32:47]
  ds_read_b64_tr_b16 v[64:65], v9 offset:0
  ds_read_b64_tr_b16 v[66:67], v9 offset:1024
  ds_read_b128 v[80:83], v5 offset:0
  ds_read_b128 v[96:99], v5 offset:8192
  v_mfma_f32_32x32x16_bf16 v[48:63], v[72:75], v[104:107], v[48:63]
  s_waitcnt lgkmcnt(4)
  v_mfma_f32_32x32x16_bf16 v[32:47], v[76:79], v[92:95], v[32:47]
  ds_read_b64_tr_b16 v[68:69], v10 offset:0
  ds_read_b64_tr_b16 v[70:71], v10 offset:1024
  ds_read_b128 v[84:87], v6 offset:0
  ds_read_b128 v[100:103], v6 offset:8192
  v_mfma_f32_32x32x16_bf16 v[48:63], v[76:79], v[108:111], v[48:63]
  s_waitcnt lgkmcnt(4)
  v_mfma_f32_32x32x16_bf16 v[32:47], v[64:67], v[80:83], v[32:47]
  ds_read_b64_tr_b16 v[72:73], v11 offset:0
  ds_read_b64_tr_b16 v[74:75], v11 offset:1024
  ds_read_b128 v[88:91], v7 offset:0
  ds_read_b128 v[104:107], v7 offset:8192
  v_mfma_f32_32x32x16_bf16 v[48:63], v[64:67], v[96:99], v[48:63]
  s_waitcnt lgkmcnt(4)
  v_mfma_f32_32x32x16_bf16 v[32:47], v[68:71], v[84:87], v[32:47]
  ds_read_b64_tr_b16 v[76:77], v12 offset:0
  ds_read_b64_tr_b16 v[78:79], v12 offset:1024
  ds_read_b128 v[92:95], v8 offset:0
  ds_read_b128 v[108:111], v8 offset:8192
  v_mfma_f32_32x32x16_bf16 v[48:63], v[68:71], v[100:103], v[48:63]
  s_waitcnt vmcnt(6)
  s_barrier
  s_min_u32 s55, s3, 6
  s_mul_i32 s52, s2, 7
  s_add_u32 s52, s52, s55
  s_add_u32 s52, s52, 0
  s_min_u32 s52, s52, 1639
  s_lshl_b32 s55, s3, 12
  s_add_u32 s55, s55, 131072
  s_mov_b32 s86, 0
  v_bfe_u32 v15, v1, 2, 2
  s_cmp_ge_u32 s52, 680
  s_nop 1
  s_cbranch_scc1 s0f4_34
  s_cmp_ge_u32 s52, 200
  s_cbranch_scc1 s0f5_35
  s_mov_b32 s89, 20
  s_mov_b32 s90, 25165824
  s_mul_i32 s87, s52, 6554
  s_lshr_b32 s87, s87, 16
  s_mul_i32 s88, s87, 10
  s_sub_u32 s88, s52, s88
  s_lshr_b32 s53, s87, 2
  s_add_u32 s53, s53, s87
  s_sub_u32 s54, s87, 16
  s_mul_i32 s54, s54, 5
  s_add_u32 s54, s54, 4
  s_cmp_ge_u32 s87, 16
  s_cselect_b32 s87, s54, s53
  s_branch s0fg_36
s0f5_35:
  s_sub_u32 s52, s52, 200
  s_mov_b32 s89, 48
  s_mov_b32 s90, 31457280
  s_mul_i32 s87, s52, 6554
  s_lshr_b32 s87, s87, 16
  s_mul_i32 s88, s87, 10
  s_sub_u32 s88, s52, s88
s0fg_36:
  v_lshrrev_b32 v14, 4, v1
  v_lshl_add_u32 v14, v14, 3, v15
  v_lshlrev_b32 v14, 7, v14
  v_and_b32 v15, 3, v1
  v_lshl_add_u32 v14, v15, 3, v14
  s_lshl_b32 s52, s88, 2
  s_add_u32 s52, s52, 0
  s_mul_i32 s53, s52, 52
  s_lshr_b32 s53, s53, 8
  s_mul_i32 s54, s53, 5
  s_sub_u32 s54, s52, s54
  s_mul_i32 s53, s53, s89
  s_add_u32 s53, s53, s87
  s_mul_i32 s53, s53, 5
  s_add_u32 s53, s53, s54
  s_lshl_b32 s53, s53, 10
  s_add_u32 s96, s53, s90
  s_lshl_b32 s52, s88, 2
  s_add_u32 s52, s52, 1
  s_mul_i32 s53, s52, 52
  s_lshr_b32 s53, s53, 8
  s_mul_i32 s54, s53, 5
  s_sub_u32 s54, s52, s54
  s_mul_i32 s53, s53, s89
  s_add_u32 s53, s53, s87
  s_mul_i32 s53, s53, 5
  s_add_u32 s53, s53, s54
  s_lshl_b32 s53, s53, 10
  s_add_u32 s97, s53, s90
  s_lshl_b32 s52, s88, 2
  s_add_u32 s52, s52, 2
  s_mul_i32 s53, s52, 52
  s_lshr_b32 s53, s53, 8
  s_mul_i32 s54, s53, 5
  s_sub_u32 s54, s52, s54
  s_mul_i32 s53, s53, s89
  s_add_u32 s53, s53, s87
  s_mul_i32 s53, s53, 5
  s_add_u32 s53, s53, s54
  s_lshl_b32 s53, s53, 10
  s_add_u32 s98, s53, s90
  s_lshl_b32 s52, s88, 2
  s_add_u32 s52, s52, 3
  s_mul_i32 s53, s52, 52
  s_lshr_b32 s53, s53, 8
  s_mul_i32 s54, s53, 5
  s_sub_u32 s54, s52, s54
  s_mul_i32 s53, s53, s89
  s_add_u32 s53, s53, s87
  s_mul_i32 s53, s53, 5
  s_add_u32 s53, s53, s54
  s_lshl_b32 s53, s53, 10
  s_add_u32 s99, s53, s90
  s_branch s0fs_37
s0f4_34:
  s_sub_u32 s52, s52, 680
  s_mul_i32 s87, s52, 2731
  s_lshr_b32 s87, s87, 16
  s_mul_i32 s88, s87, 24
  s_sub_u32 s88, s52, s88
  v_lshrrev_b32 v14, 5, v1
  v_lshl_add_u32 v14, v14, 3, v15
  v_lshlrev_b32 v14, 7, v14
  v_bfe_u32 v15, v1, 4, 1
  v_lshl_add_u32 v14, v15, 11, v14
  v_and_b32 v15, 1, v1
  v_lshl_add_u32 v14, v15, 4, v14
  v_bfe_u32 v15, v1, 1, 1
  v_lshl_add_u32 v14, v15, 3, v14
  s_lshl_b32 s52, s88, 2
  s_add_u32 s52, s52, 0
  s_mul_i32 s53, s52, 171
  s_lshr_b32 s53, s53, 9
  s_mul_i32 s54, s53, 3
  s_sub_u32 s54, s52, s54
  s_mul_i32 s53, s53, 40
  s_add_u32 s53, s53, s87
  s_mul_i32 s53, s53, 3
  s_add_u32 s53, s53, s54
  s_lshl_b32 s53, s53, 10
  s_add_u32 s96, s53, 27262976
  s_lshl_b32 s52, s88, 2
  s_add_u32 s52, s52, 1
  s_mul_i32 s53, s52, 171
  s_lshr_b32 s53, s53, 9
  s_mul_i32 s54, s53, 3
  s_sub_u32 s54, s52, s54
  s_mul_i32 s53, s53, 40
  s_add_u32 s53, s53, s87
  s_mul_i32 s53, s53, 3
  s_add_u32 s53, s53, s54
  s_lshl_b32 s53, s53, 10
  s_add_u32 s97, s53, 27262976
  s_lshl_b32 s52, s88, 2
  s_add_u32 s52, s52, 2
  s_mul_i32 s53, s52, 171
  s_lshr_b32 s53, s53, 9
  s_mul_i32 s54, s53, 3
  s_sub_u32 s54, s52, s54
  s_mul_i32 s53, s53, 40
  s_add_u32 s53, s53, s87
  s_mul_i32 s53, s53, 3
  s_add_u32 s53, s53, s54
  s_lshl_b32 s53, s53, 10
  s_add_u32 s98, s53, 27262976
  s_lshl_b32 s52, s88, 2
  s_add_u32 s52, s52, 3
  s_mul_i32 s53, s52, 171
  s_lshr_b32 s53, s53, 9
  s_mul_i32 s54, s53, 3
  s_sub_u32 s54, s52, s54
  s_mul_i32 s53, s53, 40
  s_add_u32 s53, s53, s87
  s_mul_i32 s53, s53, 3
  s_add_u32 s53, s53, s54
  s_lshl_b32 s53, s53, 10
  s_add_u32 s99, s53, 27262976
  s_mov_b32 s86, 1
s0fs_37:
  v_add_u32 v14, s55, v14
  ds_read_b64_tr_b16 v[224:225], v14 offset:0
  ds_read_b64_tr_b16 v[226:227], v14 offset:512
  ds_read_b64_tr_b16 v[228:229], v14 offset:32
  ds_read_b64_tr_b16 v[230:231], v14 offset:544
  ds_read_b64_tr_b16 v[232:233], v14 offset:64
  ds_read_b64_tr_b16 v[234:235], v14 offset:576
  ds_read_b64_tr_b16 v[236:237], v14 offset:96
  ds_read_b64_tr_b16 v[238:239], v14 offset:608
  s_waitcnt lgkmcnt(0)
  buffer_store_dwordx4 v[224:227], v2, s[32:35], s96 offen sc1
  buffer_store_dwordx4 v[228:231], v2, s[32:35], s97 offen sc1
  buffer_store_dwordx4 v[232:235], v2, s[32:35], s98 offen sc1
  buffer_store_dwordx4 v[236:239], v2, s[32:35], s99 offen sc1
  s_cmp_eq_u32 s86, 0
  s_nop 0
  s_cbranch_scc1 s0f_33
  v_mov_b32 v240, 0
  v_mov_b32 v241, 0
  v_mov_b32 v242, 0
  v_mov_b32 v243, 0
  v_dot2c_f32_bf16 v240, s94, v224
  v_dot2c_f32_bf16 v241, s94, v228
  v_dot2c_f32_bf16 v242, s94, v232
  v_dot2c_f32_bf16 v243, s94, v236
  v_dot2c_f32_bf16 v240, s94, v225
  v_dot2c_f32_bf16 v241, s94, v229
  v_dot2c_f32_bf16 v242, s94, v233
  v_dot2c_f32_bf16 v243, s94, v237
  v_dot2c_f32_bf16 v240, s94, v226
  v_dot2c_f32_bf16 v241, s94, v230
  v_dot2c_f32_bf16 v242, s94, v234
  v_dot2c_f32_bf16 v243, s94, v238
  v_dot2c_f32_bf16 v240, s94, v227
  v_dot2c_f32_bf16 v241, s94, v231
  v_dot2c_f32_bf16 v242, s94, v235
  v_dot2c_f32_bf16 v243, s94, v239
  s_nop 0
  v_permlane32_swap_b32 v240, v241
  v_add_f32 v240, v240, v241
  v_permlane32_swap_b32 v242, v243
  v_add_f32 v242, v242, v243
  v_lshlrev_b32 v14, 2, v1
  s_lshl_b32 s52, s88, 9
  s_mul_i32 s53, s87, 12288
  s_add_u32 s52, s52, s53
  s_add_u32 s52, s52, 24641536
  buffer_store_dword v240, v14, s[32:35], s52 offen offset:0 sc1
  buffer_store_dword v242, v14, s[32:35], s52 offen offset:256 sc1
s0f_33:
  s_waitcnt lgkmcnt(4)
  v_mfma_f32_32x32x16_bf16 v[32:47], v[72:75], v[88:91], v[32:47]
  ds_read_b64_tr_b16 v[64:65], v9 offset:32768
  ds_read_b64_tr_b16 v[66:67], v9 offset:33792
  ds_read_b128 v[80:83], v5 offset:32768
  ds_read_b128 v[96:99], v5 offset:40960
  v_mfma_f32_32x32x16_bf16 v[48:63], v[72:75], v[104:107], v[48:63]
  s_waitcnt lgkmcnt(4)
  v_mfma_f32_32x32x16_bf16 v[32:47], v[76:79], v[92:95], v[32:47]
  ds_read_b64_tr_b16 v[68:69], v10 offset:32768
  ds_read_b64_tr_b16 v[70:71], v10 offset:33792
  ds_read_b128 v[84:87], v6 offset:32768
  ds_read_b128 v[100:103], v6 offset:40960
  v_mfma_f32_32x32x16_bf16 v[48:63], v[76:79], v[108:111], v[48:63]
  s_waitcnt lgkmcnt(4)
  v_mfma_f32_32x32x16_bf16 v[32:47], v[64:67], v[80:83], v[32:47]
  ds_read_b64_tr_b16 v[72:73], v11 offset:32768
  ds_read_b64_tr_b16 v[74:75], v11 offset:33792
  ds_read_b128 v[88:91], v7 offset:32768
  ds_read_b128 v[104:107], v7 offset:40960
  v_mfma_f32_32x32x16_bf16 v[48:63], v[64:67], v[96:99], v[48:63]
  s_waitcnt lgkmcnt(4)
  v_mfma_f32_32x32x16_bf16 v[32:47], v[68:71], v[84:87], v[32:47]
  ds_read_b64_tr_b16 v[76:77], v12 offset:32768
  ds_read_b64_tr_b16 v[78:79], v12 offset:33792
  ds_read_b128 v[92:95], v8 offset:32768
  ds_read_b128 v[108:111], v8 offset:40960
  v_mfma_f32_32x32x16_bf16 v[48:63], v[68:71], v[100:103], v[48:63]
  s_waitcnt lgkmcnt(4)
  v_mfma_f32_32x32x16_bf16 v[32:47], v[72:75], v[88:91], v[32:47]
  v_mfma_f32_32x32x16_bf16 v[48:63], v[72:75], v[104:107], v[48:63]
  s_waitcnt lgkmcnt(0)
  v_mfma_f32_32x32x16_bf16 v[32:47], v[76:79], v[92:95], v[32:47]
  v_mfma_f32_32x32x16_bf16 v[48:63], v[76:79], v[108:111], v[48:63]
  s_waitcnt vmcnt(4)
  s_nop 10
s1J_2:
cs1c_38:
  v_xor_b32 v145, s92, v145
  v_xor_b32 v147, s92, v147
  v_xor_b32 v149, s92, v149
  v_xor_b32 v151, s92, v151
  v_xor_b32 v153, s92, v153
  v_xor_b32 v157, s92, v157
  v_xor_b32 v159, s92, v159
  v_or3_b32 v145, v145, v147, v149
  v_or3_b32 v145, v145, v151, v153
  v_or3_b32 v145, v145, v157, v159
  v_cmp_ne_u32 vcc, 0, v145
  s_nop 4
  s_cbranch_vccz cs1ok_39
  s_add_u32 s95, s95, 1
  s_cmp_gt_u32 s95, 20000
  s_cbranch_scc1 cs1ok_39
  s_sleep 4
  s_waitcnt vmcnt(0) lgkmcnt(0)
  v_and_b32 v13, 31, v1
  v_lshlrev_b32 v13, 3, v13
  v_lshrrev_b32 v14, 5, v1
  v_mul_u32_u24 v14, 76800, v14
  v_add_u32 v13, v13, v14
  s_lshl_b32 s52, s56, 10
  s_add_u32 s52, s52, 34078720
  s_lshl_b32 s53, s59, 8
  s_add_u32 s52, s52, s53
  buffer_load_dwordx2 v[144:145], v13, s[32:35], s52 offen sc1
  s_add_u32 s52, s52, 15360
  buffer_load_dwordx2 v[146:147], v13, s[32:35], s52 offen sc1
  s_add_u32 s52, s52, 15360
  buffer_load_dwordx2 v[148:149], v13, s[32:35], s52 offen sc1
  s_add_u32 s52, s52, 15360
  buffer_load_dwordx2 v[150:151], v13, s[32:35], s52 offen sc1
  s_add_u32 s52, s52, 15360
  buffer_load_dwordx2 v[152:153], v13, s[32:35], s52 offen sc1
  s_add_u32 s52, s52, 15360
  v_and_b32 v13, 31, v1
  v_lshlrev_b32 v13, 4, v13
  v_lshrrev_b32 v14, 5, v1
  v_lshl_add_u32 v13, v14, 14, v13
  s_lshl_b32 s52, s57, 10
  s_lshl_b32 s53, s60, 9
  s_add_u32 s52, s52, s53
  s_add_u32 s52, s52, 34340864
  buffer_load_dwordx4 v[156:159], v13, s[32:35], s52 offen sc1
  s_waitcnt vmcnt(0)
  s_branch cs1c_38
cs1ok_39:
  v_add_f32 v144, v144, v146
  v_add_f32 v148, v148, v150
  v_add_f32 v144, v144, v152
  v_add_f32 v144, v144, v148
  v_mov_b32 v145, v144
  s_nop 1
  v_permlane32_swap_b32 v144, v145
  v_add_f32 v144, v144, v145
  v_and_b32 v13, 31, v1
  v_lshlrev_b32 v13, 2, v13
  s_lshl_b32 s52, s3, 12
  s_add_u32 s52, s52, 131072
  v_add_u32 v13, s52, v13
  ds_write_b32 v13, v144
  v_lshrrev_b32 v14, 5, v1
  v_lshlrev_b32 v14, 4, v14
  v_add_u32 v14, s52, v14
  ds_read_b128 v[64:67], v14 offset:0
  ds_read_b128 v[68:71], v14 offset:32
  ds_read_b128 v[72:75], v14 offset:64
  ds_read_b128 v[76:79], v14 offset:96
  v_mov_b32 v28, v156
  v_mov_b32 v29, v158
  v_mov_b32 v30, v156
  v_mov_b32 v31, v158
  s_nop 0
  v_permlane32_swap_b32 v28, v30
  v_permlane32_swap_b32 v29, v31
  s_waitcnt lgkmcnt(0)
  s_cmp_lt_u32 s56, 5
  s_cselect_b32 s52, 0x3ea52b5c, 1.0
  v_mul_f32 v29, s52, v29
  v_fma_f32 v32, v28, v64, v32
  v_fma_f32 v33, v28, v65, v33
  v_fma_f32 v34, v28, v66, v34
  v_fma_f32 v35, v28, v67, v35
  v_mul_f32 v32, v29, v32
  v_mul_f32 v33, v29, v33
  v_mul_f32 v34, v29, v34
  v_mul_f32 v35, v29, v35
  v_cvt_pk_bf16_f32 v96, v32, v33
  v_cvt_pk_bf16_f32 v97, v34, v35
  buffer_store_dwordx2 v[96:97], v16, s[32:35], s76 offen sc1
  v_fma_f32 v36, v28, v68, v36
  v_fma_f32 v37, v28, v69, v37
  v_fma_f32 v38, v28, v70, v38
  v_fma_f32 v39, v28, v71, v39
  v_mul_f32 v36, v29, v36
  v_mul_f32 v37, v29, v37
  v_mul_f32 v38, v29, v38
  v_mul_f32 v39, v29, v39
  v_cvt_pk_bf16_f32 v98, v36, v37
  v_cvt_pk_bf16_f32 v99, v38, v39
  buffer_store_dwordx2 v[98:99], v17, s[32:35], s76 offen sc1
  v_fma_f32 v40, v28, v72, v40
  v_fma_f32 v41, v28, v73, v41
  v_fma_f32 v42, v28, v74, v42
  v_fma_f32 v43, v28, v75, v43
  v_mul_f32 v40, v29, v40
  v_mul_f32 v41, v29, v41
  v_mul_f32 v42, v29, v42
  v_mul_f32 v43, v29, v43
  v_cvt_pk_bf16_f32 v100, v40, v41
  v_cvt_pk_bf16_f32 v101, v42, v43
  buffer_store_dwordx2 v[100:101], v18, s[32:35], s76 offen sc1
  v_fma_f32 v44, v28, v76, v44
  v_fma_f32 v45, v28, v77, v45
  v_fma_f32 v46, v28, v78, v46
  v_fma_f32 v47, v28, v79, v47
  v_mul_f32 v44, v29, v44
  v_mul_f32 v45, v29, v45
  v_mul_f32 v46, v29, v46
  v_mul_f32 v47, v29, v47
  v_cvt_pk_bf16_f32 v102, v44, v45
  v_cvt_pk_bf16_f32 v103, v46, v47
  buffer_store_dwordx2 v[102:103], v19, s[32:35], s76 offen sc1
  s_cmp_lt_u32 s56, 5
  s_cselect_b32 s52, 0x3ea52b5c, 1.0
  v_mul_f32 v31, s52, v31
  v_fma_f32 v48, v30, v64, v48
  v_fma_f32 v49, v30, v65, v49
  v_fma_f32 v50, v30, v66, v50
  v_fma_f32 v51, v30, v67, v51
  v_mul_f32 v48, v31, v48
  v_mul_f32 v49, v31, v49
  v_mul_f32 v50, v31, v50
  v_mul_f32 v51, v31, v51
  v_cvt_pk_bf16_f32 v104, v48, v49
  v_cvt_pk_bf16_f32 v105, v50, v51
  buffer_store_dwordx2 v[104:105], v16, s[32:35], s77 offen sc1
  v_fma_f32 v52, v30, v68, v52
  v_fma_f32 v53, v30, v69, v53
  v_fma_f32 v54, v30, v70, v54
  v_fma_f32 v55, v30, v71, v55
  v_mul_f32 v52, v31, v52
  v_mul_f32 v53, v31, v53
  v_mul_f32 v54, v31, v54
  v_mul_f32 v55, v31, v55
  v_cvt_pk_bf16_f32 v106, v52, v53
  v_cvt_pk_bf16_f32 v107, v54, v55
  buffer_store_dwordx2 v[106:107], v17, s[32:35], s77 offen sc1
  v_fma_f32 v56, v30, v72, v56
  v_fma_f32 v57, v30, v73, v57
  v_fma_f32 v58, v30, v74, v58
  v_fma_f32 v59, v30, v75, v59
  v_mul_f32 v56, v31, v56
  v_mul_f32 v57, v31, v57
  v_mul_f32 v58, v31, v58
  v_mul_f32 v59, v31, v59
  v_cvt_pk_bf16_f32 v108, v56, v57
  v_cvt_pk_bf16_f32 v109, v58, v59
  buffer_store_dwordx2 v[108:109], v18, s[32:35], s77 offen sc1
  v_fma_f32 v60, v30, v76, v60
  v_fma_f32 v61, v30, v77, v61
  v_fma_f32 v62, v30, v78, v62
  v_fma_f32 v63, v30, v79, v63
  v_mul_f32 v60, v31, v60
  v_mul_f32 v61, v31, v61
  v_mul_f32 v62, v31, v62
  v_mul_f32 v63, v31, v63
  v_cvt_pk_bf16_f32 v110, v60, v61
  v_cvt_pk_bf16_f32 v111, v62, v63
  buffer_store_dwordx2 v[110:111], v19, s[32:35], s77 offen sc1
  s_nop 1
  s_branch L_tail
L_idle:
  s_sub_u32 s60, s2, 240
  s_lshl_b32 s60, s60, 3
  s_add_u32 s60, s60, s3
  v_lshrrev_b32 v3, 2, v1
  v_and_b32 v4, 3, v1
  v_mul_u32_u24 v8, 1280, v3
  v_lshl_add_u32 v8, v4, 4, v8
  s_mul_i32 s61, s60, 20480
  buffer_load_dwordx4 v[96:99], v8, s[24:27], s61 offen offset:0
  buffer_load_dwordx4 v[100:103], v8, s[24:27], s61 offen offset:64
  buffer_load_dwordx4 v[104:107], v8, s[24:27], s61 offen offset:128
  buffer_load_dwordx4 v[108:111], v8, s[24:27], s61 offen offset:192
  buffer_load_dwordx4 v[112:115], v8, s[24:27], s61 offen offset:256
  buffer_load_dwordx4 v[116:119], v8, s[24:27], s61 offen offset:320
  buffer_load_dwordx4 v[120:123], v8, s[24:27], s61 offen offset:384
  buffer_load_dwordx4 v[124:127], v8, s[24:27], s61 offen offset:448
  buffer_load_dwordx4 v[128:131], v8, s[24:27], s61 offen offset:512
  buffer_load_dwordx4 v[132:135], v8, s[24:27], s61 offen offset:576
  buffer_load_dwordx4 v[136:139], v8, s[24:27], s61 offen offset:640
  buffer_load_dwordx4 v[140:143], v8, s[24:27], s61 offen offset:704
  buffer_load_dwordx4 v[144:147], v8, s[24:27], s61 offen offset:768
  buffer_load_dwordx4 v[148:151], v8, s[24:27], s61 offen offset:832
  buffer_load_dwordx4 v[152:155], v8, s[24:27], s61 offen offset:896
  buffer_load_dwordx4 v[156:159], v8, s[24:27], s61 offen offset:960
  buffer_load_dwordx4 v[160:163], v8, s[24:27], s61 offen offset:1024
  buffer_load_dwordx4 v[164:167], v8, s[24:27], s61 offen offset:1088
  buffer_load_dwordx4 v[168:171], v8, s[24:27], s61 offen offset:1152
  buffer_load_dwordx4 v[172:175], v8, s[24:27], s61 offen offset:1216
  v_lshlrev_b32 v5, 7, v1
  s_nop 2
  s_getpc_b64 s[70:71]
L_pc_a:
  s_sub_u32 s70, s70, L_pc_a-ka_kernel
  s_subb_u32 s71, s71, 0
  s_lshl_b32 s72, s3, 13
  v_add_u32 v6, s72, v5
  v_min_u32 v6, L_end_of_code-ka_kernel-4, v6
  v_and_b32 v6, 0xfffffffc, v6
  global_load_dword v7, v6, s[70:71]
  buffer_load_dword v15, off, s[48:51], 0 sc1
  v_mov_b32 v10, 0
  v_mov_b32 v11, 0
  v_mov_b32 v12, 0
  v_mov_b32 v13, 0
  s_waitcnt vmcnt(21)
  v_dot2c_f32_bf16 v10, s94, v96
  v_dot2c_f32_bf16 v12, v96, v96
  v_dot2c_f32_bf16 v11, s94, v97
  v_dot2c_f32_bf16 v13, v97, v97
  v_dot2c_f32_bf16 v10, s94, v98
  v_dot2c_f32_bf16 v12, v98, v98
  v_dot2c_f32_bf16 v11, s94, v99
  v_dot2c_f32_bf16 v13, v99, v99
  s_waitcnt vmcnt(20)
  v_dot2c_f32_bf16 v10, s94, v100
  v_dot2c_f32_bf16 v12, v100, v100
  v_dot2c_f32_bf16 v11, s94, v101
  v_dot2c_f32_bf16 v13, v101, v101
  v_dot2c_f32_bf16 v10, s94, v102
  v_dot2c_f32_bf16 v12, v102, v102
  v_dot2c_f32_bf16 v11, s94, v103
  v_dot2c_f32_bf16 v13, v103, v103
  s_waitcnt vmcnt(19)
  v_dot2c_f32_bf16 v10, s94, v104
  v_dot2c_f32_bf16 v12, v104, v104
  v_dot2c_f32_bf16 v11, s94, v105
  v_dot2c_f32_bf16 v13, v105, v105
  v_dot2c_f32_bf16 v10, s94, v106
  v_dot2c_f32_bf16 v12, v106, v106
  v_dot2c_f32_bf16 v11, s94, v107
  v_dot2c_f32_bf16 v13, v107, v107
  s_waitcnt vmcnt(18)
  v_dot2c_f32_bf16 v10, s94, v108
  v_dot2c_f32_bf16 v12, v108, v108
  v_dot2c_f32_bf16 v11, s94, v109
  v_dot2c_f32_bf16 v13, v109, v109
  v_dot2c_f32_bf16 v10, s94, v110
  v_dot2c_f32_bf16 v12, v110, v110
  v_dot2c_f32_bf16 v11, s94, v111
  v_dot2c_f32_bf16 v13, v111, v111
  s_waitcnt vmcnt(17)
  v_dot2c_f32_bf16 v10, s94, v112
  v_dot2c_f32_bf16 v12, v112, v112
  v_dot2c_f32_bf16 v11, s94, v113
  v_dot2c_f32_bf16 v13, v113, v113
  v_dot2c_f32_bf16 v10, s94, v114
  v_dot2c_f32_bf16 v12, v114, v114
  v_dot2c_f32_bf16 v11, s94, v115
  v_dot2c_f32_bf16 v13, v115, v115
  s_waitcnt vmcnt(16)
  v_dot2c_f32_bf16 v10, s94, v116
  v_dot2c_f32_bf16 v12, v116, v116
  v_dot2c_f32_bf16 v11, s94, v117
  v_dot2c_f32_bf16 v13, v117, v117
  v_dot2c_f32_bf16 v10, s94, v118
  v_dot2c_f32_bf16 v12, v118, v118
  v_dot2c_f32_bf16 v11, s94, v119
  v_dot2c_f32_bf16 v13, v119, v119
  s_waitcnt vmcnt(15)
  v_dot2c_f32_bf16 v10, s94, v120
  v_dot2c_f32_bf16 v12, v120, v120
  v_dot2c_f32_bf16 v11, s94, v121
  v_dot2c_f32_bf16 v13, v121, v121
  v_dot2c_f32_bf16 v10, s94, v122
  v_dot2c_f32_bf16 v12, v122, v122
  v_dot2c_f32_bf16 v11, s94, v123
  v_dot2c_f32_bf16 v13, v123, v123
  s_waitcnt vmcnt(14)
  v_dot2c_f32_bf16 v10, s94, v124
  v_dot2c_f32_bf16 v12, v124, v124
  v_dot2c_f32_bf16 v11, s94, v125
  v_dot2c_f32_bf16 v13, v125, v125
  v_dot2c_f32_bf16 v10, s94, v126
  v_dot2c_f32_bf16 v12, v126, v126
  v_dot2c_f32_bf16 v11, s94, v127
  v_dot2c_f32_bf16 v13, v127, v127
  s_waitcnt vmcnt(13)
  v_dot2c_f32_bf16 v10, s94, v128
  v_dot2c_f32_bf16 v12, v128, v128
  v_dot2c_f32_bf16 v11, s94, v129
  v_dot2c_f32_bf16 v13, v129, v129
  v_dot2c_f32_bf16 v10, s94, v130
  v_dot2c_f32_bf16 v12, v130, v130
  v_dot2c_f32_bf16 v11, s94, v131
  v_dot2c_f32_bf16 v13, v131, v131
  s_waitcnt vmcnt(12)
  v_dot2c_f32_bf16 v10, s94, v132
  v_dot2c_f32_bf16 v12, v132, v132
  v_dot2c_f32_bf16 v11, s94, v133
  v_dot2c_f32_bf16 v13, v133, v133
  v_dot2c_f32_bf16 v10, s94, v134
  v_dot2c_f32_bf16 v12, v134, v134
  v_dot2c_f32_bf16 v11, s94, v135
  v_dot2c_f32_bf16 v13, v135, v135
  s_waitcnt vmcnt(11)
  v_dot2c_f32_bf16 v10, s94, v136
  v_dot2c_f32_bf16 v12, v136, v136
  v_dot2c_f32_bf16 v11, s94, v137
  v_dot2c_f32_bf16 v13, v137, v137
  v_dot2c_f32_bf16 v10, s94, v138
  v_dot2c_f32_bf16 v12, v138, v138
  v_dot2c_f32_bf16 v11, s94, v139
  v_dot2c_f32_bf16 v13, v139, v139
  s_waitcnt vmcnt(10)
  v_dot2c_f32_bf16 v10, s94, v140
  v_dot2c_f32_bf16 v12, v140, v140
  v_dot2c_f32_bf16 v11, s94, v141
  v_dot2c_f32_bf16 v13, v141, v141
  v_dot2c_f32_bf16 v10, s94, v142
  v_dot2c_f32_bf16 v12, v142, v142
  v_dot2c_f32_bf16 v11, s94, v143
  v_dot2c_f32_bf16 v13, v143, v143
  s_waitcnt vmcnt(9)
  v_dot2c_f32_bf16 v10, s94, v144
  v_dot2c_f32_bf16 v12, v144, v144
  v_dot2c_f32_bf16 v11, s94, v145
  v_dot2c_f32_bf16 v13, v145, v145
  v_dot2c_f32_bf16 v10, s94, v146
  v_dot2c_f32_bf16 v12, v146, v146
  v_dot2c_f32_bf16 v11, s94, v147
  v_dot2c_f32_bf16 v13, v147, v147
  s_waitcnt vmcnt(8)
  v_dot2c_f32_bf16 v10, s94, v148
  v_dot2c_f32_bf16 v12, v148, v148
  v_dot2c_f32_bf16 v11, s94, v149
  v_dot2c_f32_bf16 v13, v149, v149
  v_dot2c_f32_bf16 v10, s94, v150
  v_dot2c_f32_bf16 v12, v150, v150
  v_dot2c_f32_bf16 v11, s94, v151
  v_dot2c_f32_bf16 v13, v151, v151
  s_waitcnt vmcnt(7)
  v_dot2c_f32_bf16 v10, s94, v152
  v_dot2c_f32_bf16 v12, v152, v152
  v_dot2c_f32_bf16 v11, s94, v153
  v_dot2c_f32_bf16 v13, v153, v153
  v_dot2c_f32_bf16 v10, s94, v154
  v_dot2c_f32_bf16 v12, v154, v154
  v_dot2c_f32_bf16 v11, s94, v155
  v_dot2c_f32_bf16 v13, v155, v155
  s_waitcnt vmcnt(6)
  v_dot2c_f32_bf16 v10, s94, v156
  v_dot2c_f32_bf16 v12, v156, v156
  v_dot2c_f32_bf16 v11, s94, v157
  v_dot2c_f32_bf16 v13, v157, v157
  v_dot2c_f32_bf16 v10, s94, v158
  v_dot2c_f32_bf16 v12, v158, v158
  v_dot2c_f32_bf16 v11, s94, v159
  v_dot2c_f32_bf16 v13, v159, v159
  s_waitcnt vmcnt(5)
  v_dot2c_f32_bf16 v10, s94, v160
  v_dot2c_f32_bf16 v12, v160, v160
  v_dot2c_f32_bf16 v11, s94, v161
  v_dot2c_f32_bf16 v13, v161, v161
  v_dot2c_f32_bf16 v10, s94, v162
  v_dot2c_f32_bf16 v12, v162, v162
  v_dot2c_f32_bf16 v11, s94, v163
  v_dot2c_f32_bf16 v13, v163, v163
  s_waitcnt vmcnt(4)
  v_dot2c_f32_bf16 v10, s94, v164
  v_dot2c_f32_bf16 v12, v164, v164
  v_dot2c_f32_bf16 v11, s94, v165
  v_dot2c_f32_bf16 v13, v165, v165
  v_dot2c_f32_bf16 v10, s94, v166
  v_dot2c_f32_bf16 v12, v166, v166
  v_dot2c_f32_bf16 v11, s94, v167
  v_dot2c_f32_bf16 v13, v167, v167
  s_waitcnt vmcnt(3)
  v_dot2c_f32_bf16 v10, s94, v168
  v_dot2c_f32_bf16 v12, v168, v168
  v_dot2c_f32_bf16 v11, s94, v169
  v_dot2c_f32_bf16 v13, v169, v169
  v_dot2c_f32_bf16 v10, s94, v170
  v_dot2c_f32_bf16 v12, v170, v170
  v_dot2c_f32_bf16 v11, s94, v171
  v_dot2c_f32_bf16 v13, v171, v171
  s_waitcnt vmcnt(2)
  v_dot2c_f32_bf16 v10, s94, v172
  v_dot2c_f32_bf16 v12, v172, v172
  v_dot2c_f32_bf16 v11, s94, v173
  v_dot2c_f32_bf16 v13, v173, v173
  v_dot2c_f32_bf16 v10, s94, v174
  v_dot2c_f32_bf16 v12, v174, v174
  v_dot2c_f32_bf16 v11, s94, v175
  v_dot2c_f32_bf16 v13, v175, v175
  s_nop 1
  v_add_f32 v16, v10, v11
  v_add_f32 v17, v12, v13
  s_nop 0
  v_add_f32_dpp v16, v16, v16 quad_perm:[1,0,3,2] row_mask:0xf bank_mask:0xf
  v_add_f32_dpp v17, v17, v17 quad_perm:[1,0,3,2] row_mask:0xf bank_mask:0xf
  s_nop 0
  v_add_f32_dpp v16, v16, v16 quad_perm:[2,3,0,1] row_mask:0xf bank_mask:0xf
  v_add_f32_dpp v17, v17, v17 quad_perm:[2,3,0,1] row_mask:0xf bank_mask:0xf
  v_mul_f32 v16, 0xbacccccd, v16
  v_mul_f32 v17, 0x3acccccd, v17
  v_fma_f32 v17, -v16, v16, v17
  v_max_f32 v17, 0, v17
  v_add_f32 v17, 0x3727c5ac, v17
  v_rsq_f32 v17, v17
  s_waitcnt vmcnt(0)
  s_nop 1
nchk_40:
  v_readfirstlane_b32 s92, v15
  s_nop 1
  s_cmp_lg_u32 s92, 0
  s_nop 1
  s_cbranch_scc1 nok_41
  s_add_u32 s95, s95, 1
  s_cmp_gt_u32 s95, 20000
  s_cbranch_scc1 nok_41
  s_sleep 8
  s_waitcnt vmcnt(0) lgkmcnt(0)
  buffer_load_dword v15, off, s[48:51], 0 sc1
  s_waitcnt vmcnt(0)
  s_branch nchk_40
nok_41:
  v_mov_b32 v18, v17
  v_mov_b32 v17, s92
  v_mov_b32 v19, s92
  v_lshlrev_b32 v8, 4, v3
  s_lshl_b32 s61, s60, 8
  s_add_u32 s61, s61, 34340864
  v_cmp_eq_u32 vcc, 0, v4
  s_nop 1
  s_mov_b64 exec, vcc
  buffer_store_dwordx4 v[16:19], v8, s[32:35], s61 offen sc1
  s_mov_b64 exec, -1
  v_mov_b32 v20, 0
  v_mov_b32 v21, 0
  v_mov_b32 v22, 0
  v_mov_b32 v23, 0
  s_mul_i32 s61, s60, 5120
  s_add_u32 s61, s61, 20971520
  s_add_u32 s62, s61, 4096
  buffer_store_dwordx4 v[20:23], v2, s[32:35], s61 offen offset:0 sc1
  buffer_store_dwordx4 v[20:23], v2, s[32:35], s61 offen offset:1024 sc1
  buffer_store_dwordx4 v[20:23], v2, s[32:35], s61 offen offset:2048 sc1
  buffer_store_dwordx4 v[20:23], v2, s[32:35], s61 offen offset:3072 sc1
  buffer_store_dwordx4 v[20:23], v2, s[32:35], s62 offen offset:0 sc1
  s_nop 1
L_tail:
L_exit_ka_kernel:
  s_endpgm
.globl kb_kernel
.p2align 8
.type kb_kernel,@function
kb_kernel:
  s_cmp_ge_u32 s2, 256
  s_cbranch_scc1 L_exit_kb_kernel
  s_load_dwordx16 s[4:19], s[0:1], 0
  s_load_dwordx4 s[20:23], s[0:1], 64
  s_memrealtime s[96:97]
  v_and_b32 v1, 63, v0
  v_lshrrev_b32 v2, 6, v0
  s_nop 0
  v_readfirstlane_b32 s3, v2
  v_lshlrev_b32 v2, 4, v1
  s_mov_b32 s94, 0x3f803f80
  s_mov_b32 s95, 0
  s_mov_b32 s93, 0xfffffffe
  s_waitcnt lgkmcnt(0)
  s_mov_b32 s91, s96
  s_mov_b32 s24, s4
  s_and_b32 s25, s5, 0xffff
  s_mov_b32 s26, 2621440
  s_mov_b32 s27, 0x20000
  s_mov_b32 s28, s6
  s_and_b32 s29, s7, 0xffff
  s_mov_b32 s30, 2457600
  s_mov_b32 s31, 0x20000
  s_mov_b32 s32, s22
  s_and_b32 s33, s23, 0xffff
  s_mov_b32 s34, 34603008
  s_mov_b32 s35, 0x20000
  s_mov_b32 s36, s18
  s_and_b32 s37, s19, 0xffff
  s_mov_b32 s38, 2621440
  s_mov_b32 s39, 0x20000
  s_mov_b32 s48, s20
  s_and_b32 s49, s21, 0xffff
  s_mov_b32 s50, 256
  s_mov_b32 s51, 0x20000
  s_and_b32 s52, s2, 7
  s_lshr_b32 s53, s2, 3
  s_lshl_b32 s80, s52, 2
  s_lshr_b32 s54, s53, 3
  s_add_u32 s80, s80, s54
  s_and_b32 s81, s53, 7
  s_lshl_b32 s81, s81, 3
  s_lshr_b32 s54, s3, 2
  s_lshl_b32 s54, s54, 5
  s_add_u32 s54, s54, 32
  s_add_u32 s54, s54, s80
  s_mul_i32 s54, s54, 81920
  s_add_u32 s44, s22, s54
  s_addc_u32 s45, s23, 0
  s_and_b32 s45, s45, 0xffff
  s_mov_b32 s46, 81920
  s_mov_b32 s47, 0x20000
  s_and_b32 s82, s3, 3
  s_mul_i32 s82, s82, 3840
  s_lshr_b32 s54, s3, 2
  s_lshl_b32 s54, s54, 6
  s_and_b32 s55, s3, 3
  s_lshl_b32 s55, s55, 1
  s_add_u32 s54, s54, s55
  s_add_u32 s79, s54, s81
  s_mul_i32 s83, s80, 81920
  s_mul_i32 s55, s79, 640
  s_add_u32 s83, s83, s55
  s_mul_i32 s84, s79, 20480
  s_add_u32 s84, s84, 8388608
  s_add_u32 s85, s84, 1310720
  s_add_u32 s52, s81, -16
  s_mul_i32 s52, s52, 640
  s_add_u32 s52, s52, s82
  v_add_u32 v34, s52, v2
  s_mul_i32 s53, s3, 3840
  s_add_u32 m0, s53, 122880
  s_nop 0
  buffer_load_dwordx4 v34, s[44:47], 0 offen sc1 lds
  v_add_u32 v34, 1024, v34
  s_add_u32 m0, s53, 123904
  s_nop 0
  buffer_load_dwordx4 v34, s[44:47], 0 offen sc1 lds
  v_add_u32 v34, 1024, v34
  s_add_u32 m0, s53, 124928
  s_nop 0
  buffer_load_dwordx4 v34, s[44:47], 0 offen sc1 lds
  v_add_u32 v34, 1024, v34
  s_add_u32 m0, s53, 125952
  s_mov_b32 exec_hi, 0xffff
  buffer_load_dwordx4 v34, s[44:47], 0 offen sc1 lds
  s_mov_b64 exec, -1
  v_and_b32 v24, 15, v1
  v_bfe_u32 v25, v1, 4, 1
  v_lshrrev_b32 v26, 5, v1
  v_mul_u32_u24 v27, 640, v25
  v_lshlrev_b32 v28, 3, v26
  v_xor_b32 v28, v28, v24
  v_lshl_add_u32 v4, v28, 3, v27
  v_lshl_add_u32 v4, v26, 8, v4
  v_lshl_add_u32 v5, v24, 3, v27
  v_add_u32 v5, 512, v5
  v_mov_b32 v16, 0
  v_mov_b32 v17, 0
  v_mov_b32 v18, 0
  v_mov_b32 v19, 0
  buffer_load_dwordx2 v[12:13], v4, s[32:35], s83 offen
  buffer_load_dwordx2 v[14:15], v4, s[32:35], s83 offen offset:128
  s_mov_b32 exec_hi, 0
  buffer_load_dwordx2 v[16:17], v5, s[32:35], s83 offen
  s_mov_b64 exec, -1
  s_add_u32 s52, s81, 48
  s_mul_i32 s52, s52, 640
  s_add_u32 s52, s52, s82
  v_add_u32 v34, s52, v2
  s_mul_i32 s53, s3, 3840
  s_add_u32 m0, s53, 92160
  s_nop 0
  buffer_load_dwordx4 v34, s[44:47], 0 offen sc1 lds
  v_add_u32 v34, 1024, v34
  s_add_u32 m0, s53, 93184
  s_nop 0
  buffer_load_dwordx4 v34, s[44:47], 0 offen sc1 lds
  v_add_u32 v34, 1024, v34
  s_add_u32 m0, s53, 94208
  s_nop 0
  buffer_load_dwordx4 v34, s[44:47], 0 offen sc1 lds
  v_add_u32 v34, 1024, v34
  s_add_u32 m0, s53, 95232
  s_mov_b32 exec_hi, 0xffff
  buffer_load_dwordx4 v34, s[44:47], 0 offen sc1 lds
  s_mov_b64 exec, -1
  s_and_b32 s52, s2, 7
  s_lshr_b32 s53, s2, 3
  s_lshr_b32 s86, s52, 1
  s_lshl_b32 s86, s86, 3
  s_lshr_b32 s54, s53, 2
  s_add_u32 s86, s86, s54
  s_and_b32 s87, s52, 1
  s_lshl_b32 s87, s87, 2
  s_and_b32 s54, s53, 3
  s_add_u32 s87, s87, s54
  s_lshr_b32 s89, s52, 2
  s_lshl_b32 s89, s89, 2
  s_lshr_b32 s54, s53, 3
  s_add_u32 s89, s89, s54
  s_and_b32 s88, s52, 3
  s_lshl_b32 s88, s88, 3
  s_and_b32 s54, s53, 7
  s_add_u32 s88, s88, s54
  s_mul_i32 s59, s87, 245760
  s_mul_i32 s53, s3, 30720
  s_add_u32 s59, s59, s53
  s_add_u32 s59, s59, 31457280
  s_mul_i32 s52, s87, 102400
  s_mul_i32 s53, s3, 25600
  s_add_u32 s52, s52, s53
  s_add_u32 s52, s52, 25165824
  s_sub_u32 s53, s59, 3072
  s_cmp_lt_u32 s3, 4
  s_cselect_b32 s56, s52, s53
  s_mul_i32 s57, s88, 122880
  s_add_u32 s57, s57, 27262976
  s_lshl_b32 s58, s3, 10
  s_add_u32 s57, s57, s58
  s_mul_i32 s60, s86, 40960
  s_add_u32 s60, s60, 8388608
  s_and_b32 s53, s3, 3
  s_lshl_b32 s72, s53, 12
  s_lshl_b32 s73, s53, 10
  s_add_u32 s73, s73, 16384
  s_add_u32 s61, s60, 1310720
  s_lshr_b32 s52, s3, 2
  s_xor_b32 s52, s52, 1
  s_lshl_b32 s52, s52, 3
  s_add_u32 s52, s52, s89
  s_lshl_b32 s52, s52, 2
  s_and_b32 s53, s3, 3
  s_add_u32 s52, s52, s53
  s_mov_b32 s90, s52
  s_mul_i32 s62, s52, 40960
  s_add_u32 s62, s62, 11010048
  s_lshl_b32 s65, s52, 11
  s_add_u32 s65, s65, 19922944
  s_mul_i32 s66, s52, 98304
  s_mul_i32 s53, s88, 3072
  s_add_u32 s66, s66, s53
  s_add_u32 s66, s66, 13631488
  s_mul_i32 s63, s86, 98304
  s_mul_i32 s53, s3, 12288
  s_add_u32 s63, s63, s53
  s_add_u32 s63, s63, 13631488
  s_add_u32 s64, s63, 3145728
  s_and_b32 s52, s3, 3
  s_mul_i32 s52, s52, 1280
  s_lshr_b32 s53, s3, 2
  s_mul_i32 s53, s53, 30720
  s_add_u32 s52, s52, 122880
  s_sub_u32 s52, s52, s53
  v_add_u32 v6, s52, v4
  v_add_u32 v7, s52, v5
  v_bfe_u32 v27, v1, 2, 2
  v_lshl_add_u32 v27, v26, 2, v27
  v_and_b32 v28, 3, v1
  v_lshlrev_b32 v29, 7, v28
  v_lshl_add_u32 v29, v27, 3, v29
  v_and_b32 v30, 2, v28
  v_lshlrev_b32 v30, 5, v30
  v_lshlrev_b32 v31, 3, v27
  v_add_u32 v31, 512, v31
  v_cmp_eq_u32 vcc, 1, v25
  s_nop 1
  v_cndmask_b32 v29, v29, v31, vcc
  v_cndmask_b32 v30, v30, 0, vcc
  s_add_u32 s52, s52, 15360
  v_add_u32 v29, s52, v29
  v_cmp_ne_u32 s[54:55], 0, v28
  s_nop 1
  s_and_b64 vcc, vcc, s[54:55]
  v_mov_b32 v31, 2688
  v_cndmask_b32 v29, v29, v31, vcc
  v_mov_b32 v31, 640
  v_cndmask_b32 v9, v31, 0, vcc
  v_add_u32 v8, v29, v30
  v_xor_b32 v30, 64, v30
  v_add_u32 v35, v29, v30
  v_mul_u32_u24 v27, 20480, v25
  v_lshl_add_u32 v11, v24, 3, v27
  v_lshl_add_u32 v10, v24, 4, v27
  v_lshl_add_u32 v10, v26, 8, v10
  v_lshrrev_b32 v27, 4, v1
  v_lshlrev_b32 v3, 8, v27
  v_lshl_add_u32 v3, v24, 3, v3
  v_and_b32 v27, 31, v1
  v_lshlrev_b32 v28, 2, v26
  v_sub_u32 v27, v27, v28
  v_mov_b32 v28, 0xffff
  v_mov_b32 v29, 0xffff0000
  v_cmp_le_i32 s[4:5], 0, v27
  v_cmp_le_i32 s[6:7], 1, v27
  v_cmp_le_i32 s[8:9], 2, v27
  v_cmp_le_i32 s[10:11], 3, v27
  v_cmp_le_i32 s[12:13], 8, v27
  v_cmp_le_i32 s[14:15], 9, v27
  v_cmp_le_i32 s[16:17], 10, v27
  v_cmp_le_i32 s[18:19], 11, v27
  v_cmp_le_i32 s[20:21], 16, v27
  v_cmp_le_i32 s[22:23], 17, v27
  v_cmp_le_i32 s[28:29], 18, v27
  v_cmp_le_i32 s[30:31], 19, v27
  v_cmp_le_i32 s[40:41], 24, v27
  v_cmp_le_i32 s[42:43], 25, v27
  v_cmp_le_i32 s[44:45], 26, v27
  v_cmp_le_i32 s[46:47], 27, v27
  v_cndmask_b32 v30, 0, v28, s[4:5]
  v_cndmask_b32 v31, 0, v29, s[6:7]
  v_or_b32 v20, v30, v31
  v_cndmask_b32 v30, 0, v28, s[8:9]
  v_cndmask_b32 v31, 0, v29, s[10:11]
  v_or_b32 v21, v30, v31
  v_cndmask_b32 v30, 0, v28, s[12:13]
  v_cndmask_b32 v31, 0, v29, s[14:15]
  v_or_b32 v22, v30, v31
  v_cndmask_b32 v30, 0, v28, s[16:17]
  v_cndmask_b32 v31, 0, v29, s[18:19]
  v_or_b32 v23, v30, v31
  v_cndmask_b32 v30, 0, v28, s[20:21]
  v_cndmask_b32 v31, 0, v29, s[22:23]
  v_or_b32 v24, v30, v31
  v_cndmask_b32 v30, 0, v28, s[28:29]
  v_cndmask_b32 v31, 0, v29, s[30:31]
  v_or_b32 v25, v30, v31
  v_cndmask_b32 v30, 0, v28, s[40:41]
  v_cndmask_b32 v31, 0, v29, s[42:43]
  v_or_b32 v26, v30, v31
  v_cndmask_b32 v30, 0, v28, s[44:45]
  v_cndmask_b32 v31, 0, v29, s[46:47]
  v_or_b32 v27, v30, v31
  v_mov_b32 v142, 0
  v_mov_b32 v143, 0
  v_mov_b32 v37, 2816
  ds_write_b64 v37, v[142:143]
  ds_write_b64 v37, v[142:143] offset:8
  ds_write_b64 v37, v[142:143] offset:16
  v_mov_b32 v142, s94
  v_and_b32 v37, 31, v1
  v_lshlrev_b32 v37, 2, v37
  ds_write_b32 v37, v142 offset:2688
  v_mov_b32 v42, 0
  v_mov_b32 v43, 0
  v_mov_b32 v50, 0
  v_mov_b32 v51, 0
  s_waitcnt lgkmcnt(0)
  s_waitcnt vmcnt(0)
  s_barrier
  s_cmp_ge_u32 s3, 4
  s_cbranch_scc1 g1pre_42
  s_setprio 0
  s_branch g1pre_42_j
g1pre_42:
  s_sub_u32 s57, s57, 4096
  s_sub_u32 s58, s58, 4096
  s_add_u32 m0, s58, 3072
  s_add_u32 s100, s57, 3072
  buffer_load_dwordx4 v2, s[32:35], s100 offen sc1 lds
  s_add_u32 m0, s58, 7168
  s_add_u32 s100, s57, 7168
  buffer_load_dwordx4 v2, s[32:35], s100 offen sc1 lds
  s_add_u32 m0, s58, 11264
  s_add_u32 s100, s57, 11264
  buffer_load_dwordx4 v2, s[32:35], s100 offen sc1 lds
  s_add_u32 m0, s58, 15360
  s_add_u32 s100, s57, 15360
  buffer_load_dwordx4 v2, s[32:35], s100 offen sc1 lds
  s_add_u32 m0, s58, 19456
  s_add_u32 s100, s57, 19456
  buffer_load_dwordx4 v2, s[32:35], s100 offen sc1 lds
  s_add_u32 m0, s58, 23552
  s_add_u32 s100, s57, 23552
  buffer_load_dwordx4 v2, s[32:35], s100 offen sc1 lds
  s_add_u32 m0, s58, 27648
  s_add_u32 s100, s57, 27648
  buffer_load_dwordx4 v2, s[32:35], s100 offen sc1 lds
  s_add_u32 m0, s58, 31744
  s_add_u32 s100, s57, 31744
  buffer_load_dwordx4 v2, s[32:35], s100 offen sc1 lds
  s_add_u32 m0, s58, 35840
  s_add_u32 s100, s57, 35840
  buffer_load_dwordx4 v2, s[32:35], s100 offen sc1 lds
  s_add_u32 m0, s58, 39936
  s_add_u32 s100, s57, 39936
  buffer_load_dwordx4 v2, s[32:35], s100 offen sc1 lds
  s_add_u32 m0, s58, 44032
  s_add_u32 s100, s57, 44032
  buffer_load_dwordx4 v2, s[32:35], s100 offen sc1 lds
  s_add_u32 m0, s58, 48128
  s_add_u32 s100, s57, 48128
  buffer_load_dwordx4 v2, s[32:35], s100 offen sc1 lds
  s_add_u32 m0, s58, 52224
  s_add_u32 s100, s57, 52224
  buffer_load_dwordx4 v2, s[32:35], s100 offen sc1 lds
  s_add_u32 m0, s58, 56320
  s_add_u32 s100, s57, 56320
  buffer_load_dwordx4 v2, s[32:35], s100 offen sc1 lds
  s_add_u32 m0, s58, 60416
  s_add_u32 s100, s57, 60416
  buffer_load_dwordx4 v2, s[32:35], s100 offen sc1 lds
  s_add_u32 m0, s58, 64512
  s_add_u32 s100, s57, 64512
  buffer_load_dwordx4 v2, s[32:35], s100 offen sc1 lds
  s_add_u32 m0, s58, 68608
  s_add_u32 s100, s57, 68608
  buffer_load_dwordx4 v2, s[32:35], s100 offen sc1 lds
  s_add_u32 m0, s58, 72704
  s_add_u32 s100, s57, 72704
  buffer_load_dwordx4 v2, s[32:35], s100 offen sc1 lds
  s_add_u32 m0, s58, 76800
  s_add_u32 s100, s57, 76800
  buffer_load_dwordx4 v2, s[32:35], s100 offen sc1 lds
  s_add_u32 m0, s58, 80896
  s_add_u32 s100, s57, 80896
  buffer_load_dwordx4 v2, s[32:35], s100 offen sc1 lds
  s_add_u32 m0, s58, 84992
  s_add_u32 s100, s57, 84992
  buffer_load_dwordx4 v2, s[32:35], s100 offen sc1 lds
  s_add_u32 m0, s58, 88064
  s_add_u32 s100, s57, 88064
  buffer_load_dwordx4 v2, s[32:35], s100 offen sc1 lds
  v_lshrrev_b32 v30, 1, v2
  s_mul_i32 s52, s58, 120
  s_mul_i32 s53, s88, 384
  s_add_u32 s52, s52, s53
  s_add_u32 s52, s52, 24641536
  buffer_load_dwordx2 v[200:201], v30, s[32:35], s52 offen
  s_add_u32 s52, s52, 12288
  buffer_load_dwordx2 v[202:203], v30, s[32:35], s52 offen
  s_add_u32 s52, s52, 12288
  buffer_load_dwordx2 v[204:205], v30, s[32:35], s52 offen
  s_add_u32 s52, s52, 12288
  buffer_load_dwordx2 v[206:207], v30, s[32:35], s52 offen
  s_add_u32 s52, s52, 12288
  buffer_load_dwordx2 v[208:209], v30, s[32:35], s52 offen
  s_add_u32 s52, s52, 12288
  buffer_load_dwordx2 v[210:211], v30, s[32:35], s52 offen
  s_add_u32 s52, s52, 12288
  buffer_load_dwordx2 v[212:213], v30, s[32:35], s52 offen
  s_add_u32 s52, s52, 12288
  buffer_load_dwordx2 v[214:215], v30, s[32:35], s52 offen
  s_add_u32 s52, s52, 12288
  buffer_load_dwordx2 v[216:217], v30, s[32:35], s52 offen
  s_add_u32 s52, s52, 12288
  buffer_load_dwordx2 v[218:219], v30, s[32:35], s52 offen
  s_add_u32 s52, s52, 12288
g1pre_42_j:
  s_cmp_lt_u32 s3, 4
  s_cselect_b64 vcc, -1, 0
  ds_read2_b64 v[36:39], v6 offset0:0 offset1:16
  ds_read_b64 v[40:41], v7 offset:0
  ds_read_b64 v[44:45], v6 offset:10240
  ds_read_b64 v[46:47], v6 offset:10368
  ds_read_b64 v[48:49], v7 offset:10240
  s_waitcnt lgkmcnt(3)
  v_mfma_f32_32x32x16_bf16 v[84:99], v[36:39], v[12:15], 0
  v_mfma_f32_32x32x16_bf16 v[84:99], v[40:43], v[16:19], v[84:99]
  ds_read_b64 v[36:37], v6 offset:8960
  ds_read_b64 v[38:39], v6 offset:9088
  ds_read_b64 v[40:41], v7 offset:8960
  s_waitcnt lgkmcnt(3)
  v_mfma_f32_32x32x16_bf16 v[100:115], v[44:47], v[12:15], 0
  v_mfma_f32_32x32x16_bf16 v[100:115], v[48:51], v[16:19], v[100:115]
  ds_read_b64 v[44:45], v6 offset:7680
  ds_read_b64 v[46:47], v6 offset:7808
  ds_read_b64 v[48:49], v7 offset:7680
  s_cmp_lt_u32 s79, 16
  s_cbranch_scc1 fv_44
fv_44_r:
  s_nop 6
  v_cndmask_b32 v100, v84, v100, s[4:5]
  v_cndmask_b32 v101, v85, v101, s[6:7]
  v_cndmask_b32 v102, v86, v102, s[8:9]
  v_cndmask_b32 v103, v87, v103, s[10:11]
  v_cndmask_b32 v104, v88, v104, s[12:13]
  v_cndmask_b32 v105, v89, v105, s[14:15]
  v_cndmask_b32 v106, v90, v106, s[16:17]
  v_cndmask_b32 v107, v91, v107, s[18:19]
  v_cndmask_b32 v108, v92, v108, s[20:21]
  v_cndmask_b32 v109, v93, v109, s[22:23]
  v_cndmask_b32 v110, v94, v110, s[28:29]
  v_cndmask_b32 v111, v95, v111, s[30:31]
  v_cndmask_b32 v112, v96, v112, s[40:41]
  v_cndmask_b32 v113, v97, v113, s[42:43]
  v_cndmask_b32 v114, v98, v114, s[44:45]
  v_cndmask_b32 v115, v99, v115, s[46:47]
  s_waitcnt lgkmcnt(3)
  v_mfma_f32_32x32x16_bf16 v[84:99], v[36:39], v[12:15], 0
  v_max_f32 v32, v100, v101
  v_max_f32 v33, v102, v103
  v_max3_f32 v32, v104, v105, v32
  v_max3_f32 v33, v106, v107, v33
  v_mfma_f32_32x32x16_bf16 v[84:99], v[40:43], v[16:19], v[84:99]
  ds_read_b64 v[36:37], v6 offset:6400
  ds_read_b64 v[38:39], v6 offset:6528
  ds_read_b64 v[40:41], v7 offset:6400
  v_max3_f32 v32, v108, v109, v32
  v_max3_f32 v33, v110, v111, v33
  v_max3_f32 v32, v112, v113, v32
  v_max3_f32 v33, v114, v115, v33
  s_cbranch_vccz wps_45
  buffer_load_dwordx4 v[156:159], v2, s[32:35], s56 offen offset:0 sc1
wps_45:
  s_cmp_lt_u32 s79, 2
  s_cbranch_scc1 pad_46
  s_waitcnt lgkmcnt(3)
  v_mfma_f32_32x32x16_bf16 v[100:115], v[44:47], v[12:15], 0
  v_max3_f32 v32, v84, v85, v32
  v_max3_f32 v33, v86, v87, v33
  v_max3_f32 v32, v88, v89, v32
  v_max3_f32 v33, v90, v91, v33
  v_mfma_f32_32x32x16_bf16 v[100:115], v[48:51], v[16:19], v[100:115]
  ds_read_b64 v[44:45], v6 offset:5120
  ds_read_b64 v[46:47], v6 offset:5248
  ds_read_b64 v[48:49], v7 offset:5120
  v_max3_f32 v32, v92, v93, v32
  v_max3_f32 v33, v94, v95, v33
  v_max3_f32 v32, v96, v97, v32
  v_max3_f32 v33, v98, v99, v33
  s_cbranch_vccz wps_47
  buffer_load_dwordx4 v[160:163], v2, s[32:35], s56 offen offset:1024 sc1
wps_47:
  s_cmp_lt_u32 s79, 4
  s_cbranch_scc1 pad_48
  s_waitcnt lgkmcnt(3)
  v_mfma_f32_32x32x16_bf16 v[84:99], v[36:39], v[12:15], 0
  v_max3_f32 v32, v100, v101, v32
  v_max3_f32 v33, v102, v103, v33
  v_max3_f32 v32, v104, v105, v32
  v_max3_f32 v33, v106, v107, v33
  v_mfma_f32_32x32x16_bf16 v[84:99], v[40:43], v[16:19], v[84:99]
  ds_read_b64 v[36:37], v6 offset:3840
  ds_read_b64 v[38:39], v6 offset:3968
  ds_read_b64 v[40:41], v7 offset:3840
  v_max3_f32 v32, v108, v109, v32
  v_max3_f32 v33, v110, v111, v33
  v_max3_f32 v32, v112, v113, v32
  v_max3_f32 v33, v114, v115, v33
  s_cbranch_vccz wps_49
  buffer_load_dwordx4 v[164:167], v2, s[32:35], s56 offen offset:2048 sc1
wps_49:
  s_cmp_lt_u32 s79, 6
  s_cbranch_scc1 pad_50
  s_waitcnt lgkmcnt(3)
  v_mfma_f32_32x32x16_bf16 v[100:115], v[44:47], v[12:15], 0
  v_max3_f32 v32, v84, v85, v32
  v_max3_f32 v33, v86, v87, v33
  v_max3_f32 v32, v88, v89, v32
  v_max3_f32 v33, v90, v91, v33
  v_mfma_f32_32x32x16_bf16 v[100:115], v[48:51], v[16:19], v[100:115]
  ds_read_b64 v[44:45], v6 offset:2560
  ds_read_b64 v[46:47], v6 offset:2688
  ds_read_b64 v[48:49], v7 offset:2560
  v_max3_f32 v32, v92, v93, v32
  v_max3_f32 v33, v94, v95, v33
  v_max3_f32 v32, v96, v97, v32
  v_max3_f32 v33, v98, v99, v33
  s_cbranch_vccz wps_51
  buffer_load_dwordx4 v[168:171], v2, s[32:35], s56 offen offset:3072 sc1
wps_51:
  s_cmp_lt_u32 s79, 8
  s_cbranch_scc1 pad_52
  s_waitcnt lgkmcnt(3)
  v_mfma_f32_32x32x16_bf16 v[84:99], v[36:39], v[12:15], 0
  v_max3_f32 v32, v100, v101, v32
  v_max3_f32 v33, v102, v103, v33
  v_max3_f32 v32, v104, v105, v32
  v_max3_f32 v33, v106, v107, v33
  v_mfma_f32_32x32x16_bf16 v[84:99], v[40:43], v[16:19], v[84:99]
  ds_read2_b64 v[36:39], v6 offset0:160 offset1:176
  ds_read_b64 v[40:41], v7 offset:1280
  v_max3_f32 v32, v108, v109, v32
  v_max3_f32 v33, v110, v111, v33
  v_max3_f32 v32, v112, v113, v32
  v_max3_f32 v33, v114, v115, v33
  s_cbranch_vccz wps_53
  s_add_u32 s100, s56, 4096
  buffer_load_dwordx4 v[172:175], v2, s[32:35], s100 offen offset:0 sc1
wps_53:
  s_cmp_lt_u32 s79, 10
  s_cbranch_scc1 pad_54
  s_waitcnt lgkmcnt(2)
  v_mfma_f32_32x32x16_bf16 v[100:115], v[44:47], v[12:15], 0
  s_nop 0
  v_max3_f32 v32, v84, v85, v32
  v_max3_f32 v33, v86, v87, v33
  v_max3_f32 v32, v88, v89, v32
  v_max3_f32 v33, v90, v91, v33
  v_mfma_f32_32x32x16_bf16 v[100:115], v[48:51], v[16:19], v[100:115]
  v_max3_f32 v32, v92, v93, v32
  v_max3_f32 v33, v94, v95, v33
  v_max3_f32 v32, v96, v97, v32
  v_max3_f32 v33, v98, v99, v33
  s_cbranch_vccz wps_55
  s_add_u32 s100, s56, 4096
  buffer_load_dwordx4 v[176:179], v2, s[32:35], s100 offen offset:1024 sc1
wps_55:
  s_cmp_lt_u32 s79, 12
  s_cbranch_scc1 pad_56
  s_waitcnt lgkmcnt(0)
  v_mfma_f32_32x32x16_bf16 v[84:99], v[36:39], v[12:15], 0
  s_nop 2
  v_max3_f32 v32, v100, v101, v32
  v_max3_f32 v33, v102, v103, v33
  v_max3_f32 v32, v104, v105, v32
  v_max3_f32 v33, v106, v107, v33
  v_mfma_f32_32x32x16_bf16 v[84:99], v[40:43], v[16:19], v[84:99]
  v_max3_f32 v32, v108, v109, v32
  v_max3_f32 v33, v110, v111, v33
  v_max3_f32 v32, v112, v113, v32
  v_max3_f32 v33, v114, v115, v33
  s_cbranch_vccz wps_57
  s_add_u32 s100, s56, 4096
  buffer_load_dwordx4 v[180:183], v2, s[32:35], s100 offen offset:2048 sc1
wps_57:
  s_cmp_lt_u32 s79, 14
  s_cbranch_scc1 pad_58
  s_nop 4
  v_max3_f32 v32, v84, v85, v32
  v_max3_f32 v33, v86, v87, v33
  v_max3_f32 v32, v88, v89, v32
  v_max3_f32 v33, v90, v91, v33
  v_max3_f32 v32, v92, v93, v32
  v_max3_f32 v33, v94, v95, v33
  v_max3_f32 v32, v96, v97, v32
  v_max3_f32 v33, v98, v99, v33
  s_cbranch_vccz wps_59
  s_add_u32 s100, s56, 4096
  buffer_load_dwordx4 v[184:187], v2, s[32:35], s100 offen offset:3072 sc1
wps_59:
  s_nop 1
p1done_43:
  s_waitcnt lgkmcnt(0)
  ds_read2_b64 v[36:39], v6 offset0:0 offset1:16
  ds_read_b64 v[40:41], v7 offset:0
  ds_read_b64 v[44:45], v6 offset:10240
  ds_read_b64 v[46:47], v6 offset:10368
  ds_read_b64 v[48:49], v7 offset:10240
  v_max_f32 v32, v32, v33
  v_mov_b32 v33, v32
  s_nop 1
  v_permlane32_swap_b32 v32, v33
  v_max_f32 v32, v32, v33
  v_sub_f32 v116, 0, v32
  v_sub_f32 v117, 0, v32
  v_sub_f32 v118, 0, v32
  v_sub_f32 v119, 0, v32
  v_sub_f32 v120, 0, v32
  v_sub_f32 v121, 0, v32
  v_sub_f32 v122, 0, v32
  v_sub_f32 v123, 0, v32
  v_sub_f32 v124, 0, v32
  v_sub_f32 v125, 0, v32
  v_sub_f32 v126, 0, v32
  v_sub_f32 v127, 0, v32
  v_sub_f32 v128, 0, v32
  v_sub_f32 v129, 0, v32
  v_sub_f32 v130, 0, v32
  v_sub_f32 v131, 0, v32
  s_waitcnt lgkmcnt(3)
  s_nop 0
  v_mfma_f32_32x32x16_bf16 v[84:99], v[36:39], v[12:15], v[116:131]
  v_mfma_f32_32x32x16_bf16 v[84:99], v[40:43], v[16:19], v[84:99]
  ds_read_b64 v[36:37], v6 offset:8960
  ds_read_b64 v[38:39], v6 offset:9088
  ds_read_b64 v[40:41], v7 offset:8960
  s_waitcnt lgkmcnt(3)
  v_mfma_f32_32x32x16_bf16 v[100:115], v[44:47], v[12:15], v[116:131]
  v_mfma_f32_32x32x16_bf16 v[100:115], v[48:51], v[16:19], v[100:115]
  ds_read_b64 v[44:45], v6 offset:7680
  ds_read_b64 v[46:47], v6 offset:7808
  ds_read_b64 v[48:49], v7 offset:7680
  v_mad_u32_u24 v30, v9, 0, v8
  v_mad_u32_u24 v31, v9, 0, v35
  ds_read_b64_tr_b16 v[52:53], v30
  ds_read_b64_tr_b16 v[54:55], v31
  v_mad_u32_u24 v30, v9, 1, v8
  v_mad_u32_u24 v31, v9, 1, v35
  ds_read_b64_tr_b16 v[56:57], v30
  ds_read_b64_tr_b16 v[58:59], v31
  v_mad_u32_u24 v30, v9, 16, v8
  v_mad_u32_u24 v31, v9, 16, v35
  ds_read_b64_tr_b16 v[60:61], v30
  ds_read_b64_tr_b16 v[62:63], v31
  v_mad_u32_u24 v30, v9, 17, v8
  v_mad_u32_u24 v31, v9, 17, v35
  ds_read_b64_tr_b16 v[64:65], v30
  ds_read_b64_tr_b16 v[66:67], v31
  s_cmp_lt_u32 s79, 16
  s_cbranch_scc1 fv_61
fv_61_r:
  v_cndmask_b32 v100, v84, v100, s[4:5]
  v_cndmask_b32 v101, v85, v101, s[6:7]
  v_cndmask_b32 v102, v86, v102, s[8:9]
  v_cndmask_b32 v103, v87, v103, s[10:11]
  v_cndmask_b32 v104, v88, v104, s[12:13]
  v_cndmask_b32 v105, v89, v105, s[14:15]
  v_cndmask_b32 v106, v90, v106, s[16:17]
  v_cndmask_b32 v107, v91, v107, s[18:19]
  v_cndmask_b32 v108, v92, v108, s[20:21]
  v_cndmask_b32 v109, v93, v109, s[22:23]
  v_cndmask_b32 v110, v94, v110, s[28:29]
  v_cndmask_b32 v111, v95, v111, s[30:31]
  v_cndmask_b32 v112, v96, v112, s[40:41]
  v_cndmask_b32 v113, v97, v113, s[42:43]
  v_cndmask_b32 v114, v98, v114, s[44:45]
  v_cndmask_b32 v115, v99, v115, s[46:47]
  s_waitcnt lgkmcnt(11)
  v_mfma_f32_32x32x16_bf16 v[84:99], v[36:39], v[12:15], v[116:131]
  v_exp_f32 v100, v100
  v_exp_f32 v101, v101
  v_exp_f32 v102, v102
  v_exp_f32 v103, v103
  v_exp_f32 v104, v104
  v_exp_f32 v105, v105
  v_exp_f32 v106, v106
  v_exp_f32 v107, v107
  v_mfma_f32_32x32x16_bf16 v[84:99], v[40:43], v[16:19], v[84:99]
  ds_read_b64 v[36:37], v6 offset:6400
  ds_read_b64 v[38:39], v6 offset:6528
  ds_read_b64 v[40:41], v7 offset:6400
  v_exp_f32 v108, v108
  v_exp_f32 v109, v109
  v_exp_f32 v110, v110
  v_exp_f32 v111, v111
  v_exp_f32 v112, v112
  v_exp_f32 v113, v113
  v_exp_f32 v114, v114
  v_exp_f32 v115, v115
  s_cbranch_vccz wps_62
  s_add_u32 s100, s56, 8192
  buffer_load_dwordx4 v[188:191], v2, s[32:35], s100 offen offset:0 sc1
wps_62:
  v_cvt_pk_bf16_f32 v76, v100, v101
  v_cvt_pk_bf16_f32 v77, v102, v103
  v_cvt_pk_bf16_f32 v78, v104, v105
  v_cvt_pk_bf16_f32 v79, v106, v107
  v_cvt_pk_bf16_f32 v80, v108, v109
  v_cvt_pk_bf16_f32 v81, v110, v111
  v_cvt_pk_bf16_f32 v82, v112, v113
  v_cvt_pk_bf16_f32 v83, v114, v115
  s_cbranch_vccz wps_63
  s_add_u32 s100, s56, 8192
  buffer_load_dwordx4 v[192:195], v2, s[32:35], s100 offen offset:1024 sc1
wps_63:
  v_bfi_b32 v148, v20, 0, v76
  v_bfi_b32 v149, v21, 0, v77
  v_bfi_b32 v150, v22, 0, v78
  v_bfi_b32 v151, v23, 0, v79
  v_bfi_b32 v152, v24, 0, v80
  v_bfi_b32 v153, v25, 0, v81
  v_bfi_b32 v154, v26, 0, v82
  v_bfi_b32 v155, v27, 0, v83
  v_and_b32 v76, v20, v76
  v_and_b32 v77, v21, v77
  v_and_b32 v78, v22, v78
  v_and_b32 v79, v23, v79
  v_and_b32 v80, v24, v80
  v_and_b32 v81, v25, v81
  v_and_b32 v82, v26, v82
  v_and_b32 v83, v27, v83
  s_cmp_lt_u32 s79, 2
  s_cbranch_scc1 pad_65
  s_waitcnt lgkmcnt(11)
  v_mfma_f32_32x32x16_bf16 v[100:115], v[44:47], v[12:15], v[116:131]
  v_exp_f32 v84, v84
  v_exp_f32 v85, v85
  v_exp_f32 v86, v86
  v_mfma_f32_32x32x16_bf16 v[100:115], v[48:51], v[16:19], v[100:115]
  ds_read_b64 v[44:45], v6 offset:5120
  ds_read_b64 v[46:47], v6 offset:5248
  ds_read_b64 v[48:49], v7 offset:5120
  v_exp_f32 v87, v87
  v_exp_f32 v88, v88
  v_exp_f32 v89, v89
  s_waitcnt lgkmcnt(10)
  v_mfma_f32_32x32x16_bf16 v[132:147], v[52:55], v[148:151], 0
  v_exp_f32 v90, v90
  v_exp_f32 v91, v91
  v_exp_f32 v92, v92
  v_mfma_f32_32x32x16_bf16 v[132:147], v[56:59], v[152:155], v[132:147]
  v_mad_u32_u24 v30, v9, 14, v8
  v_mad_u32_u24 v31, v9, 14, v35
  ds_read_b64_tr_b16 v[52:53], v30
  ds_read_b64_tr_b16 v[54:55], v31
  v_mad_u32_u24 v30, v9, 15, v8
  v_mad_u32_u24 v31, v9, 15, v35
  ds_read_b64_tr_b16 v[56:57], v30
  ds_read_b64_tr_b16 v[58:59], v31
  v_exp_f32 v93, v93
  v_exp_f32 v94, v94
  v_exp_f32 v95, v95
  s_waitcnt lgkmcnt(10)
  v_mfma_f32_32x32x16_bf16 v[132:147], v[60:63], v[76:79], v[132:147]
  v_exp_f32 v96, v96
  v_exp_f32 v97, v97
  v_exp_f32 v98, v98
  v_mfma_f32_32x32x16_bf16 v[132:147], v[64:67], v[80:83], v[132:147]
  v_mad_u32_u24 v30, v9, 12, v8
  v_mad_u32_u24 v31, v9, 12, v35
  ds_read_b64_tr_b16 v[60:61], v30
  ds_read_b64_tr_b16 v[62:63], v31
  v_mad_u32_u24 v30, v9, 13, v8
  v_mad_u32_u24 v31, v9, 13, v35
  ds_read_b64_tr_b16 v[64:65], v30
  ds_read_b64_tr_b16 v[66:67], v31
  v_exp_f32 v99, v99
  s_cbranch_vccz wps_66
  s_add_u32 s100, s56, 8192
  buffer_load_dwordx4 v[196:199], v2, s[32:35], s100 offen offset:2048 sc1
wps_66:
  v_cvt_pk_bf16_f32 v68, v84, v85
  v_cvt_pk_bf16_f32 v69, v86, v87
  v_cvt_pk_bf16_f32 v70, v88, v89
  v_cvt_pk_bf16_f32 v71, v90, v91
  v_cvt_pk_bf16_f32 v72, v92, v93
  v_cvt_pk_bf16_f32 v73, v94, v95
  v_cvt_pk_bf16_f32 v74, v96, v97
  v_cvt_pk_bf16_f32 v75, v98, v99
  s_cbranch_vccz wps_67
  s_add_u32 s100, s56, 8192
  buffer_load_dwordx4 v[200:203], v2, s[32:35], s100 offen offset:3072 sc1
wps_67:
  s_cmp_lt_u32 s79, 4
  s_cbranch_scc1 pad_69
  s_waitcnt lgkmcnt(11)
  v_mfma_f32_32x32x16_bf16 v[84:99], v[36:39], v[12:15], v[116:131]
  v_exp_f32 v100, v100
  v_exp_f32 v101, v101
  v_exp_f32 v102, v102
  v_exp_f32 v103, v103
  v_mfma_f32_32x32x16_bf16 v[84:99], v[40:43], v[16:19], v[84:99]
  ds_read_b64 v[36:37], v6 offset:3840
  ds_read_b64 v[38:39], v6 offset:3968
  ds_read_b64 v[40:41], v7 offset:3840
  v_exp_f32 v104, v104
  v_exp_f32 v105, v105
  v_exp_f32 v106, v106
  v_exp_f32 v107, v107
  s_waitcnt lgkmcnt(7)
  v_mfma_f32_32x32x16_bf16 v[132:147], v[52:55], v[68:71], v[132:147]
  v_exp_f32 v108, v108
  v_exp_f32 v109, v109
  v_exp_f32 v110, v110
  v_exp_f32 v111, v111
  v_mfma_f32_32x32x16_bf16 v[132:147], v[56:59], v[72:75], v[132:147]
  v_mad_u32_u24 v30, v9, 10, v8
  v_mad_u32_u24 v31, v9, 10, v35
  ds_read_b64_tr_b16 v[52:53], v30
  ds_read_b64_tr_b16 v[54:55], v31
  v_mad_u32_u24 v30, v9, 11, v8
  v_mad_u32_u24 v31, v9, 11, v35
  ds_read_b64_tr_b16 v[56:57], v30
  ds_read_b64_tr_b16 v[58:59], v31
  v_exp_f32 v112, v112
  v_exp_f32 v113, v113
  v_exp_f32 v114, v114
  v_exp_f32 v115, v115
  s_cbranch_vccz wps_70
  s_add_u32 s100, s56, 12288
  buffer_load_dwordx4 v[204:207], v2, s[32:35], s100 offen offset:0 sc1
wps_70:
  v_cvt_pk_bf16_f32 v76, v100, v101
  v_cvt_pk_bf16_f32 v77, v102, v103
  v_cvt_pk_bf16_f32 v78, v104, v105
  v_cvt_pk_bf16_f32 v79, v106, v107
  v_cvt_pk_bf16_f32 v80, v108, v109
  v_cvt_pk_bf16_f32 v81, v110, v111
  v_cvt_pk_bf16_f32 v82, v112, v113
  v_cvt_pk_bf16_f32 v83, v114, v115
  s_cbranch_vccz wps_71
  s_add_u32 s100, s56, 12288
  buffer_load_dwordx4 v[208:211], v2, s[32:35], s100 offen offset:1024 sc1
wps_71:
  s_cmp_lt_u32 s79, 6
  s_cbranch_scc1 pad_73
  v_mfma_f32_32x32x16_bf16 v[100:115], v[44:47], v[12:15], v[116:131]
  v_exp_f32 v84, v84
  v_exp_f32 v85, v85
  v_exp_f32 v86, v86
  v_exp_f32 v87, v87
  v_mfma_f32_32x32x16_bf16 v[100:115], v[48:51], v[16:19], v[100:115]
  ds_read_b64 v[44:45], v6 offset:2560
  ds_read_b64 v[46:47], v6 offset:2688
  ds_read_b64 v[48:49], v7 offset:2560
  v_exp_f32 v88, v88
  v_exp_f32 v89, v89
  v_exp_f32 v90, v90
  v_exp_f32 v91, v91
  s_waitcnt lgkmcnt(10)
  v_mfma_f32_32x32x16_bf16 v[132:147], v[60:63], v[76:79], v[132:147]
  v_exp_f32 v92, v92
  v_exp_f32 v93, v93
  v_exp_f32 v94, v94
  v_exp_f32 v95, v95
  v_mfma_f32_32x32x16_bf16 v[132:147], v[64:67], v[80:83], v[132:147]
  v_mad_u32_u24 v30, v9, 8, v8
  v_mad_u32_u24 v31, v9, 8, v35
  ds_read_b64_tr_b16 v[60:61], v30
  ds_read_b64_tr_b16 v[62:63], v31
  v_mad_u32_u24 v30, v9, 9, v8
  v_mad_u32_u24 v31, v9, 9, v35
  ds_read_b64_tr_b16 v[64:65], v30
  ds_read_b64_tr_b16 v[66:67], v31
  v_exp_f32 v96, v96
  v_exp_f32 v97, v97
  v_exp_f32 v98, v98
  v_exp_f32 v99, v99
  s_cbranch_vccz wps_74
  s_add_u32 s100, s56, 12288
  buffer_load_dwordx4 v[212:215], v2, s[32:35], s100 offen offset:2048 sc1
wps_74:
  v_cvt_pk_bf16_f32 v68, v84, v85
  v_cvt_pk_bf16_f32 v69, v86, v87
  v_cvt_pk_bf16_f32 v70, v88, v89
  v_cvt_pk_bf16_f32 v71, v90, v91
  v_cvt_pk_bf16_f32 v72, v92, v93
  v_cvt_pk_bf16_f32 v73, v94, v95
  v_cvt_pk_bf16_f32 v74, v96, v97
  v_cvt_pk_bf16_f32 v75, v98, v99
  s_cbranch_vccz wps_75
  s_add_u32 s100, s56, 12288
  buffer_load_dwordx4 v[216:219], v2, s[32:35], s100 offen offset:3072 sc1
wps_75:
  s_cmp_lt_u32 s79, 8
  s_cbranch_scc1 pad_77
  s_waitcnt lgkmcnt(11)
  v_mfma_f32_32x32x16_bf16 v[84:99], v[36:39], v[12:15], v[116:131]
  v_exp_f32 v100, v100
  v_exp_f32 v101, v101
  v_exp_f32 v102, v102
  v_exp_f32 v103, v103
  v_mfma_f32_32x32x16_bf16 v[84:99], v[40:43], v[16:19], v[84:99]
  ds_read2_b64 v[36:39], v6 offset0:160 offset1:176
  ds_read_b64 v[40:41], v7 offset:1280
  v_exp_f32 v104, v104
  v_exp_f32 v105, v105
  v_exp_f32 v106, v106
  v_exp_f32 v107, v107
  s_waitcnt lgkmcnt(9)
  v_mfma_f32_32x32x16_bf16 v[132:147], v[52:55], v[68:71], v[132:147]
  v_exp_f32 v108, v108
  v_exp_f32 v109, v109
  v_exp_f32 v110, v110
  v_exp_f32 v111, v111
  v_mfma_f32_32x32x16_bf16 v[132:147], v[56:59], v[72:75], v[132:147]
  v_mad_u32_u24 v30, v9, 6, v8
  v_mad_u32_u24 v31, v9, 6, v35
  ds_read_b64_tr_b16 v[52:53], v30
  ds_read_b64_tr_b16 v[54:55], v31
  v_mad_u32_u24 v30, v9, 7, v8
  v_mad_u32_u24 v31, v9, 7, v35
  ds_read_b64_tr_b16 v[56:57], v30
  ds_read_b64_tr_b16 v[58:59], v31
  v_exp_f32 v112, v112
  v_exp_f32 v113, v113
  v_exp_f32 v114, v114
  v_exp_f32 v115, v115
  s_cbranch_vccz wps_78
  s_add_u32 s100, s56, 16384
  buffer_load_dwordx4 v[220:223], v2, s[32:35], s100 offen offset:0 sc1
wps_78:
  v_cvt_pk_bf16_f32 v76, v100, v101
  v_cvt_pk_bf16_f32 v77, v102, v103
  v_cvt_pk_bf16_f32 v78, v104, v105
  v_cvt_pk_bf16_f32 v79, v106, v107
  v_cvt_pk_bf16_f32 v80, v108, v109
  v_cvt_pk_bf16_f32 v81, v110, v111
  v_cvt_pk_bf16_f32 v82, v112, v113
  v_cvt_pk_bf16_f32 v83, v114, v115
  s_cbranch_vccz wps_79
  s_add_u32 s100, s56, 16384
  buffer_load_dwordx4 v[224:227], v2, s[32:35], s100 offen offset:1024 sc1
wps_79:
  s_cmp_lt_u32 s79, 10
  s_cbranch_scc1 pad_81
  s_waitcnt lgkmcnt(10)
  v_mfma_f32_32x32x16_bf16 v[100:115], v[44:47], v[12:15], v[116:131]
  v_exp_f32 v84, v84
  v_exp_f32 v85, v85
  v_exp_f32 v86, v86
  v_exp_f32 v87, v87
  v_mfma_f32_32x32x16_bf16 v[100:115], v[48:51], v[16:19], v[100:115]
  v_exp_f32 v88, v88
  v_exp_f32 v89, v89
  v_exp_f32 v90, v90
  v_exp_f32 v91, v91
  s_waitcnt lgkmcnt(6)
  v_mfma_f32_32x32x16_bf16 v[132:147], v[60:63], v[76:79], v[132:147]
  v_exp_f32 v92, v92
  v_exp_f32 v93, v93
  v_exp_f32 v94, v94
  v_exp_f32 v95, v95
  v_mfma_f32_32x32x16_bf16 v[132:147], v[64:67], v[80:83], v[132:147]
  v_mad_u32_u24 v30, v9, 4, v8
  v_mad_u32_u24 v31, v9, 4, v35
  ds_read_b64_tr_b16 v[60:61], v30
  ds_read_b64_tr_b16 v[62:63], v31
  v_mad_u32_u24 v30, v9, 5, v8
  v_mad_u32_u24 v31, v9, 5, v35
  ds_read_b64_tr_b16 v[64:65], v30
  ds_read_b64_tr_b16 v[66:67], v31
  v_exp_f32 v96, v96
  v_exp_f32 v97, v97
  v_exp_f32 v98, v98
  v_exp_f32 v99, v99
  s_cbranch_vccz wps_82
  s_add_u32 s100, s56, 16384
  buffer_load_dwordx4 v[228:231], v2, s[32:35], s100 offen offset:2048 sc1
wps_82:
  v_cvt_pk_bf16_f32 v68, v84, v85
  v_cvt_pk_bf16_f32 v69, v86, v87
  v_cvt_pk_bf16_f32 v70, v88, v89
  v_cvt_pk_bf16_f32 v71, v90, v91
  v_cvt_pk_bf16_f32 v72, v92, v93
  v_cvt_pk_bf16_f32 v73, v94, v95
  v_cvt_pk_bf16_f32 v74, v96, v97
  v_cvt_pk_bf16_f32 v75, v98, v99
  s_cbranch_vccz wps_83
  s_add_u32 s100, s56, 16384
  buffer_load_dwordx4 v[232:235], v2, s[32:35], s100 offen offset:3072 sc1
wps_83:
  s_cmp_lt_u32 s79, 12
  s_cbranch_scc1 pad_85
  s_waitcnt lgkmcnt(8)
  v_mfma_f32_32x32x16_bf16 v[84:99], v[36:39], v[12:15], v[116:131]
  v_exp_f32 v100, v100
  v_exp_f32 v101, v101
  v_exp_f32 v102, v102
  v_exp_f32 v103, v103
  v_mfma_f32_32x32x16_bf16 v[84:99], v[40:43], v[16:19], v[84:99]
  v_exp_f32 v104, v104
  v_exp_f32 v105, v105
  v_exp_f32 v106, v106
  v_exp_f32 v107, v107
  s_waitcnt lgkmcnt(4)
  v_mfma_f32_32x32x16_bf16 v[132:147], v[52:55], v[68:71], v[132:147]
  v_exp_f32 v108, v108
  v_exp_f32 v109, v109
  v_exp_f32 v110, v110
  v_exp_f32 v111, v111
  v_mfma_f32_32x32x16_bf16 v[132:147], v[56:59], v[72:75], v[132:147]
  v_mad_u32_u24 v30, v9, 2, v8
  v_mad_u32_u24 v31, v9, 2, v35
  ds_read_b64_tr_b16 v[52:53], v30
  ds_read_b64_tr_b16 v[54:55], v31
  v_mad_u32_u24 v30, v9, 3, v8
  v_mad_u32_u24 v31, v9, 3, v35
  ds_read_b64_tr_b16 v[56:57], v30
  ds_read_b64_tr_b16 v[58:59], v31
  v_exp_f32 v112, v112
  v_exp_f32 v113, v113
  v_exp_f32 v114, v114
  v_exp_f32 v115, v115
  s_cbranch_vccz wps_86
  s_add_u32 s100, s56, 20480
  buffer_load_dwordx4 v[236:239], v2, s[32:35], s100 offen offset:0 sc1
wps_86:
  v_cvt_pk_bf16_f32 v76, v100, v101
  v_cvt_pk_bf16_f32 v77, v102, v103
  v_cvt_pk_bf16_f32 v78, v104, v105
  v_cvt_pk_bf16_f32 v79, v106, v107
  v_cvt_pk_bf16_f32 v80, v108, v109
  v_cvt_pk_bf16_f32 v81, v110, v111
  v_cvt_pk_bf16_f32 v82, v112, v113
  v_cvt_pk_bf16_f32 v83, v114, v115
  s_cbranch_vccz wps_87
  s_add_u32 s100, s56, 20480
  buffer_load_dwordx4 v[240:243], v2, s[32:35], s100 offen offset:1024 sc1
wps_87:
  s_cmp_lt_u32 s79, 14
  s_cbranch_scc1 pad_89
  s_waitcnt lgkmcnt(4)
  v_mfma_f32_32x32x16_bf16 v[132:147], v[60:63], v[76:79], v[132:147]
  v_exp_f32 v84, v84
  v_exp_f32 v85, v85
  v_exp_f32 v86, v86
  v_exp_f32 v87, v87
  v_exp_f32 v88, v88
  v_exp_f32 v89, v89
  v_exp_f32 v90, v90
  v_exp_f32 v91, v91
  v_mfma_f32_32x32x16_bf16 v[132:147], v[64:67], v[80:83], v[132:147]
  v_exp_f32 v92, v92
  v_exp_f32 v93, v93
  v_exp_f32 v94, v94
  v_exp_f32 v95, v95
  v_exp_f32 v96, v96
  v_exp_f32 v97, v97
  v_exp_f32 v98, v98
  v_exp_f32 v99, v99
  s_cbranch_vccz wps_90
  s_add_u32 s100, s56, 20480
  buffer_load_dwordx4 v[244:247], v2, s[32:35], s100 offen offset:2048 sc1
wps_90:
  v_cvt_pk_bf16_f32 v68, v84, v85
  v_cvt_pk_bf16_f32 v69, v86, v87
  v_cvt_pk_bf16_f32 v70, v88, v89
  v_cvt_pk_bf16_f32 v71, v90, v91
  v_cvt_pk_bf16_f32 v72, v92, v93
  v_cvt_pk_bf16_f32 v73, v94, v95
  v_cvt_pk_bf16_f32 v74, v96, v97
  v_cvt_pk_bf16_f32 v75, v98, v99
  s_cbranch_vccz wps_91
  s_add_u32 s100, s56, 20480
  buffer_load_dwordx4 v[248:251], v2, s[32:35], s100 offen offset:3072 sc1
wps_91:
  s_cbranch_vccz wps_92
  s_add_u32 s100, s56, 24576
  buffer_load_dwordx4 v[252:255], v2, s[32:35], s100 offen offset:0 sc1
wps_92:
  s_waitcnt lgkmcnt(0)
  v_mfma_f32_32x32x16_bf16 v[132:147], v[52:55], v[68:71], v[132:147]
  v_mfma_f32_32x32x16_bf16 v[132:147], v[56:59], v[72:75], v[132:147]
  s_nop 11
  s_branch p2done_60
fv_44:
  s_nop 15
  v_mov_b32 v84, 0xff800000
  v_mov_b32 v85, 0xff800000
  v_mov_b32 v86, 0xff800000
  v_mov_b32 v87, 0xff800000
  v_mov_b32 v88, 0xff800000
  v_mov_b32 v89, 0xff800000
  v_mov_b32 v90, 0xff800000
  v_mov_b32 v91, 0xff800000
  v_mov_b32 v92, 0xff800000
  v_mov_b32 v93, 0xff800000
  v_mov_b32 v94, 0xff800000
  v_mov_b32 v95, 0xff800000
  v_mov_b32 v96, 0xff800000
  v_mov_b32 v97, 0xff800000
  v_mov_b32 v98, 0xff800000
  v_mov_b32 v99, 0xff800000
  s_nop 2
  s_branch fv_44_r
pad_46:
  s_nop 15
  s_branch p1done_43
pad_48:
  s_nop 15
  s_branch p1done_43
pad_50:
  s_nop 15
  s_branch p1done_43
pad_52:
  s_nop 15
  s_branch p1done_43
pad_54:
  s_nop 15
  s_branch p1done_43
pad_56:
  s_nop 15
  s_branch p1done_43
pad_58:
  s_nop 15
  s_branch p1done_43
fv_61:
  s_nop 15
  v_mov_b32 v84, 0xff800000
  v_mov_b32 v85, 0xff800000
  v_mov_b32 v86, 0xff800000
  v_mov_b32 v87, 0xff800000
  v_mov_b32 v88, 0xff800000
  v_mov_b32 v89, 0xff800000
  v_mov_b32 v90, 0xff800000
  v_mov_b32 v91, 0xff800000
  v_mov_b32 v92, 0xff800000
  v_mov_b32 v93, 0xff800000
  v_mov_b32 v94, 0xff800000
  v_mov_b32 v95, 0xff800000
  v_mov_b32 v96, 0xff800000
  v_mov_b32 v97, 0xff800000
  v_mov_b32 v98, 0xff800000
  v_mov_b32 v99, 0xff800000
  s_nop 2
  s_branch fv_61_r
pad_65:
  s_nop 15
  s_branch p2t_64
pad_69:
  s_nop 15
  s_branch p2t_68
pad_73:
  s_nop 15
  s_branch p2t_72
pad_77:
  s_nop 15
  s_branch p2t_76
pad_81:
  s_nop 15
  s_branch p2t_80
pad_85:
  s_nop 15
  s_branch p2t_84
pad_89:
  s_nop 15
  s_branch p2t_88
p2t_64:
  s_waitcnt lgkmcnt(0)
  v_mfma_f32_32x32x16_bf16 v[132:147], v[52:55], v[148:151], 0
  v_mfma_f32_32x32x16_bf16 v[132:147], v[56:59], v[152:155], v[132:147]
  v_mfma_f32_32x32x16_bf16 v[132:147], v[60:63], v[76:79], v[132:147]
  v_mfma_f32_32x32x16_bf16 v[132:147], v[64:67], v[80:83], v[132:147]
  s_nop 11
  s_branch p2done_60_w
p2t_68:
  s_waitcnt lgkmcnt(0)
  v_mfma_f32_32x32x16_bf16 v[132:147], v[52:55], v[68:71], v[132:147]
  v_mfma_f32_32x32x16_bf16 v[132:147], v[56:59], v[72:75], v[132:147]
  s_nop 11
  s_branch p2done_60_w
p2t_72:
  s_waitcnt lgkmcnt(0)
  v_mfma_f32_32x32x16_bf16 v[132:147], v[60:63], v[76:79], v[132:147]
  v_mfma_f32_32x32x16_bf16 v[132:147], v[64:67], v[80:83], v[132:147]
  s_nop 11
  s_branch p2done_60_w
p2t_76:
  s_waitcnt lgkmcnt(0)
  v_mfma_f32_32x32x16_bf16 v[132:147], v[52:55], v[68:71], v[132:147]
  v_mfma_f32_32x32x16_bf16 v[132:147], v[56:59], v[72:75], v[132:147]
  s_nop 11
  s_branch p2done_60_w
p2t_80:
  s_waitcnt lgkmcnt(0)
  v_mfma_f32_32x32x16_bf16 v[132:147], v[60:63], v[76:79], v[132:147]
  v_mfma_f32_32x32x16_bf16 v[132:147], v[64:67], v[80:83], v[132:147]
  s_nop 11
  s_branch p2done_60_w
p2t_84:
  s_waitcnt lgkmcnt(0)
  v_mfma_f32_32x32x16_bf16 v[132:147], v[52:55], v[68:71], v[132:147]
  v_mfma_f32_32x32x16_bf16 v[132:147], v[56:59], v[72:75], v[132:147]
  s_nop 11
  s_branch p2done_60_w
p2t_88:
  s_waitcnt lgkmcnt(0)
  v_mfma_f32_32x32x16_bf16 v[132:147], v[60:63], v[76:79], v[132:147]
  v_mfma_f32_32x32x16_bf16 v[132:147], v[64:67], v[80:83], v[132:147]
  s_nop 11
  s_branch p2done_60_w
p2done_60_w:
p2done_60:
  s_lshr_b32 s52, s3, 2
  s_lshl_b32 s52, s52, 2
  s_add_u32 s52, s52, 2824
  s_waitcnt lgkmcnt(0)
  v_mov_b32 v30, s52
  v_mov_b32 v31, 1
  s_mov_b64 exec, 1
  ds_add_u32 v30, v31
  s_mov_b64 exec, -1
  v_rcp_f32 v32, v144
  s_nop 0
  v_mul_f32 v132, v132, v32
  v_mul_f32 v133, v133, v32
  v_mul_f32 v134, v134, v32
  v_mul_f32 v135, v135, v32
  v_mul_f32 v136, v136, v32
  v_mul_f32 v137, v137, v32
  v_mul_f32 v138, v138, v32
  v_mul_f32 v139, v139, v32
  v_mul_f32 v140, v140, v32
  v_mul_f32 v141, v141, v32
  v_mul_f32 v142, v142, v32
  v_mul_f32 v143, v143, v32
  v_cvt_pk_bf16_f32 v68, v132, v133
  v_cvt_pk_bf16_f32 v69, v134, v135
  v_cvt_pk_bf16_f32 v70, v136, v137
  v_cvt_pk_bf16_f32 v71, v138, v139
  v_cvt_pk_bf16_f32 v72, v140, v141
  v_cvt_pk_bf16_f32 v73, v142, v143
  v_permlane32_swap_b32 v68, v70
  v_permlane32_swap_b32 v69, v71
  s_lshl_b32 s52, s80, 9
  s_add_u32 s52, s52, s84
  s_lshl_b32 s53, s80, 7
  s_add_u32 s53, s53, s84
  s_add_u32 s53, s53, 16384
  buffer_store_dwordx4 v[68:71], v10, s[32:35], s52 offen sc1
  s_mov_b32 exec_hi, 0
  buffer_store_dwordx2 v[72:73], v11, s[32:35], s53 offen sc1
  s_mov_b64 exec, -1
  s_lshl_b32 s52, s79, 11
  s_lshl_b32 s53, s80, 7
  s_add_u32 s52, s52, s53
  s_add_u32 s52, s52, 20971520
  s_waitcnt vmcnt(0)
  v_mov_b32 v30, 1
  s_mov_b64 exec, 1
  buffer_store_dword v30, off, s[32:35], s52 sc1
  s_mov_b64 exec, -1
  s_cmp_ge_u32 s79, 14
  s_cbranch_scc1 wpre_93
  buffer_load_dwordx4 v[156:159], v2, s[32:35], s56 offen offset:0 sc1
  buffer_load_dwordx4 v[160:163], v2, s[32:35], s56 offen offset:1024 sc1
  buffer_load_dwordx4 v[164:167], v2, s[32:35], s56 offen offset:2048 sc1
  buffer_load_dwordx4 v[168:171], v2, s[32:35], s56 offen offset:3072 sc1
  s_add_u32 s100, s56, 4096
  buffer_load_dwordx4 v[172:175], v2, s[32:35], s100 offen offset:0 sc1
  s_add_u32 s100, s56, 4096
  buffer_load_dwordx4 v[176:179], v2, s[32:35], s100 offen offset:1024 sc1
  s_add_u32 s100, s56, 4096
  buffer_load_dwordx4 v[180:183], v2, s[32:35], s100 offen offset:2048 sc1
  s_add_u32 s100, s56, 4096
  buffer_load_dwordx4 v[184:187], v2, s[32:35], s100 offen offset:3072 sc1
  s_add_u32 s100, s56, 8192
  buffer_load_dwordx4 v[188:191], v2, s[32:35], s100 offen offset:0 sc1
  s_add_u32 s100, s56, 8192
  buffer_load_dwordx4 v[192:195], v2, s[32:35], s100 offen offset:1024 sc1
  s_add_u32 s100, s56, 8192
  buffer_load_dwordx4 v[196:199], v2, s[32:35], s100 offen offset:2048 sc1
  s_add_u32 s100, s56, 8192
  buffer_load_dwordx4 v[200:203], v2, s[32:35], s100 offen offset:3072 sc1
  s_add_u32 s100, s56, 12288
  buffer_load_dwordx4 v[204:207], v2, s[32:35], s100 offen offset:0 sc1
  s_add_u32 s100, s56, 12288
  buffer_load_dwordx4 v[208:211], v2, s[32:35], s100 offen offset:1024 sc1
  s_add_u32 s100, s56, 12288
  buffer_load_dwordx4 v[212:215], v2, s[32:35], s100 offen offset:2048 sc1
  s_add_u32 s100, s56, 12288
  buffer_load_dwordx4 v[216:219], v2, s[32:35], s100 offen offset:3072 sc1
  s_add_u32 s100, s56, 16384
  buffer_load_dwordx4 v[220:223], v2, s[32:35], s100 offen offset:0 sc1
  s_add_u32 s100, s56, 16384
  buffer_load_dwordx4 v[224:227], v2, s[32:35], s100 offen offset:1024 sc1
  s_add_u32 s100, s56, 16384
  buffer_load_dwordx4 v[228:231], v2, s[32:35], s100 offen offset:2048 sc1
  s_add_u32 s100, s56, 16384
  buffer_load_dwordx4 v[232:235], v2, s[32:35], s100 offen offset:3072 sc1
  s_add_u32 s100, s56, 20480
  buffer_load_dwordx4 v[236:239], v2, s[32:35], s100 offen offset:0 sc1
  s_add_u32 s100, s56, 20480
  buffer_load_dwordx4 v[240:243], v2, s[32:35], s100 offen offset:1024 sc1
  s_add_u32 s100, s56, 20480
  buffer_load_dwordx4 v[244:247], v2, s[32:35], s100 offen offset:2048 sc1
  s_add_u32 s100, s56, 20480
  buffer_load_dwordx4 v[248:251], v2, s[32:35], s100 offen offset:3072 sc1
  s_add_u32 s100, s56, 24576
  buffer_load_dwordx4 v[252:255], v2, s[32:35], s100 offen offset:0 sc1
wpre_93:
  s_cmp_ge_u32 s3, 4
  s_cbranch_scc1 s3g1_94
  s_setprio 2
  s_mul_i32 s52, s3, 10240
  s_add_u32 s52, s52, 122880
  v_add_u32 v4, s52, v2
  v_bfe_u32 v6, v1, 4, 1
  v_mul_u32_u24 v6, 5120, v6
  v_lshrrev_b32 v7, 5, v1
  v_lshl_add_u32 v6, v7, 9, v6
  v_and_b32 v7, 15, v1
  v_lshl_add_u32 v8, v7, 4, v6
  v_and_b32 v6, 31, v1
  v_mul_u32_u24 v6, 1280, v6
  v_lshrrev_b32 v7, 5, v1
  v_lshl_add_u32 v9, v7, 4, v6
  v_add_u32 v8, s58, v8
  v_add_u32 v8, 122880, v8
  s_lshr_b32 s52, s58, 5
  v_add_u32 v9, s52, v9
  s_mul_i32 s52, s86, 40960
  s_mul_i32 s53, s87, 160
  s_add_u32 s52, s52, s53
  s_add_u32 s53, s52, 1310720
  buffer_load_dwordx4 v[12:15], v9, s[24:27], s52 offen
  buffer_load_dwordx4 v[16:19], v9, s[24:27], s52 offen offset:128
  buffer_load_dwordx4 v[20:23], v9, s[24:27], s53 offen
  buffer_load_dwordx4 v[24:27], v9, s[24:27], s53 offen offset:128
  s_mul_i32 s67, s86, 40960
  s_mul_i32 s53, s87, 5120
  s_add_u32 s67, s67, s53
  s_add_u32 s67, s67, s58
  s_add_u32 s67, s67, 11010048
  s_add_u32 s68, s67, 1310720
  s_lshl_b32 s101, s86, 12
  s_lshl_b32 s52, s3, 10
  s_add_u32 s101, s101, s52
  s_add_u32 s101, s101, 20971520
  v_and_b32 v6, 7, v1
  v_lshlrev_b32 v6, 7, v6
  s_nop 2
prb_96:
  buffer_load_dword v7, v6, s[32:35], s101 offen sc1
  s_waitcnt vmcnt(0)
  v_cmp_eq_u32 vcc, 0, v7
  s_nop 4
  s_cbranch_vccz prbok_97
  s_sleep 8
  s_add_u32 s95, s95, 1
  s_cmp_gt_u32 s95, 20000
  s_cbranch_scc0 prb_96
prbok_97:
  s_add_u32 s100, s60, s72
  buffer_load_dwordx4 v[68:71], v2, s[32:35], s100 offen offset:0 sc1
  s_add_u32 s100, s60, s72
  s_add_u32 s100, s100, 20480
  buffer_load_dwordx4 v[72:75], v2, s[32:35], s100 offen offset:0 sc1
  s_add_u32 s100, s60, s72
  buffer_load_dwordx4 v[76:79], v2, s[32:35], s100 offen offset:1024 sc1
  s_add_u32 s100, s60, s72
  s_add_u32 s100, s100, 20480
  buffer_load_dwordx4 v[80:83], v2, s[32:35], s100 offen offset:1024 sc1
  s_add_u32 s100, s60, s72
  buffer_load_dwordx4 v[84:87], v2, s[32:35], s100 offen offset:2048 sc1
  s_add_u32 s100, s60, s72
  s_add_u32 s100, s100, 20480
  buffer_load_dwordx4 v[88:91], v2, s[32:35], s100 offen offset:2048 sc1
  s_add_u32 s100, s60, s72
  buffer_load_dwordx4 v[92:95], v2, s[32:35], s100 offen offset:3072 sc1
  s_add_u32 s100, s60, s72
  s_add_u32 s100, s100, 20480
  buffer_load_dwordx4 v[96:99], v2, s[32:35], s100 offen offset:3072 sc1
  s_add_u32 s100, s60, s73
  buffer_load_dwordx2 v[100:101], v3, s[32:35], s100 offen offset:0 sc1
  buffer_load_dwordx2 v[102:103], v3, s[32:35], s100 offen offset:128 sc1
  s_add_u32 s100, s60, s73
  s_add_u32 s100, s100, 20480
  buffer_load_dwordx2 v[104:105], v3, s[32:35], s100 offen offset:0 sc1
  buffer_load_dwordx2 v[106:107], v3, s[32:35], s100 offen offset:128 sc1
s3v_98:
  s_waitcnt vmcnt(10)
  v_mfma_f32_16x16x32_bf16 v[28:31], v[156:159], v[68:71], 0
  v_mfma_f32_16x16x32_bf16 v[32:35], v[160:163], v[68:71], 0
  v_mfma_f32_16x16x32_bf16 v[36:39], v[164:167], v[68:71], 0
  v_mfma_f32_16x16x32_bf16 v[40:43], v[168:171], v[68:71], 0
  v_mfma_f32_16x16x32_bf16 v[44:47], v[172:175], v[68:71], 0
  v_mfma_f32_16x16x32_bf16 v[48:51], v[156:159], v[72:75], 0
  v_mfma_f32_16x16x32_bf16 v[52:55], v[160:163], v[72:75], 0
  v_mfma_f32_16x16x32_bf16 v[56:59], v[164:167], v[72:75], 0
  v_mfma_f32_16x16x32_bf16 v[60:63], v[168:171], v[72:75], 0
  v_mfma_f32_16x16x32_bf16 v[64:67], v[172:175], v[72:75], 0
  s_waitcnt vmcnt(8)
  v_mfma_f32_16x16x32_bf16 v[28:31], v[176:179], v[76:79], v[28:31]
  v_mfma_f32_16x16x32_bf16 v[32:35], v[180:183], v[76:79], v[32:35]
  v_mfma_f32_16x16x32_bf16 v[36:39], v[184:187], v[76:79], v[36:39]
  v_mfma_f32_16x16x32_bf16 v[40:43], v[188:191], v[76:79], v[40:43]
  v_mfma_f32_16x16x32_bf16 v[44:47], v[192:195], v[76:79], v[44:47]
  v_mfma_f32_16x16x32_bf16 v[48:51], v[176:179], v[80:83], v[48:51]
  v_mfma_f32_16x16x32_bf16 v[52:55], v[180:183], v[80:83], v[52:55]
  v_mfma_f32_16x16x32_bf16 v[56:59], v[184:187], v[80:83], v[56:59]
  v_mfma_f32_16x16x32_bf16 v[60:63], v[188:191], v[80:83], v[60:63]
  v_mfma_f32_16x16x32_bf16 v[64:67], v[192:195], v[80:83], v[64:67]
  s_waitcnt vmcnt(6)
  v_mfma_f32_16x16x32_bf16 v[28:31], v[196:199], v[84:87], v[28:31]
  v_mfma_f32_16x16x32_bf16 v[32:35], v[200:203], v[84:87], v[32:35]
  v_mfma_f32_16x16x32_bf16 v[36:39], v[204:207], v[84:87], v[36:39]
  v_mfma_f32_16x16x32_bf16 v[40:43], v[208:211], v[84:87], v[40:43]
  v_mfma_f32_16x16x32_bf16 v[44:47], v[212:215], v[84:87], v[44:47]
  v_mfma_f32_16x16x32_bf16 v[48:51], v[196:199], v[88:91], v[48:51]
  v_mfma_f32_16x16x32_bf16 v[52:55], v[200:203], v[88:91], v[52:55]
  v_mfma_f32_16x16x32_bf16 v[56:59], v[204:207], v[88:91], v[56:59]
  v_mfma_f32_16x16x32_bf16 v[60:63], v[208:211], v[88:91], v[60:63]
  v_mfma_f32_16x16x32_bf16 v[64:67], v[212:215], v[88:91], v[64:67]
  s_waitcnt vmcnt(4)
  v_mfma_f32_16x16x32_bf16 v[28:31], v[216:219], v[92:95], v[28:31]
  v_mfma_f32_16x16x32_bf16 v[32:35], v[220:223], v[92:95], v[32:35]
  v_mfma_f32_16x16x32_bf16 v[36:39], v[224:227], v[92:95], v[36:39]
  v_mfma_f32_16x16x32_bf16 v[40:43], v[228:231], v[92:95], v[40:43]
  v_mfma_f32_16x16x32_bf16 v[44:47], v[232:235], v[92:95], v[44:47]
  v_mfma_f32_16x16x32_bf16 v[48:51], v[216:219], v[96:99], v[48:51]
  v_mfma_f32_16x16x32_bf16 v[52:55], v[220:223], v[96:99], v[52:55]
  v_mfma_f32_16x16x32_bf16 v[56:59], v[224:227], v[96:99], v[56:59]
  v_mfma_f32_16x16x32_bf16 v[60:63], v[228:231], v[96:99], v[60:63]
  v_mfma_f32_16x16x32_bf16 v[64:67], v[232:235], v[96:99], v[64:67]
  s_waitcnt vmcnt(0)
  v_mfma_f32_16x16x32_bf16 v[28:31], v[236:239], v[100:103], v[28:31]
  v_mfma_f32_16x16x32_bf16 v[32:35], v[240:243], v[100:103], v[32:35]
  v_mfma_f32_16x16x32_bf16 v[36:39], v[244:247], v[100:103], v[36:39]
  v_mfma_f32_16x16x32_bf16 v[40:43], v[248:251], v[100:103], v[40:43]
  v_mfma_f32_16x16x32_bf16 v[44:47], v[252:255], v[100:103], v[44:47]
  v_mfma_f32_16x16x32_bf16 v[48:51], v[236:239], v[104:107], v[48:51]
  v_mfma_f32_16x16x32_bf16 v[52:55], v[240:243], v[104:107], v[52:55]
  v_mfma_f32_16x16x32_bf16 v[56:59], v[244:247], v[104:107], v[56:59]
  v_mfma_f32_16x16x32_bf16 v[60:63], v[248:251], v[104:107], v[60:63]
  v_mfma_f32_16x16x32_bf16 v[64:67], v[252:255], v[104:107], v[64:67]
  v_mov_b32 v6, 2824
  s_nop 6
gw_99:
  ds_read_b32 v7, v6
  s_waitcnt lgkmcnt(0)
  v_readfirstlane_b32 s52, v7
  s_nop 1
  s_cmp_ge_u32 s52, 4
  s_nop 1
  s_cbranch_scc1 gwok_100
  s_sleep 1
  s_add_u32 s95, s95, 1
  s_cmp_gt_u32 s95, 1000000
  s_cbranch_scc0 gw_99
gwok_100:
  ds_write_b128 v4, v[28:31] offset:0
  ds_write_b128 v4, v[32:35] offset:1024
  ds_write_b128 v4, v[36:39] offset:2048
  ds_write_b128 v4, v[40:43] offset:3072
  ds_write_b128 v4, v[44:47] offset:4096
  ds_write_b128 v4, v[48:51] offset:5120
  ds_write_b128 v4, v[52:55] offset:6144
  ds_write_b128 v4, v[56:59] offset:7168
  ds_write_b128 v4, v[60:63] offset:8192
  ds_write_b128 v4, v[64:67] offset:9216
  s_waitcnt lgkmcnt(0)
  v_mov_b32 v6, 2816
  v_mov_b32 v7, 1
  s_mov_b64 exec, 1
  ds_add_u32 v6, v7
  s_mov_b64 exec, -1
  s_lshl_b32 s101, s86, 12
  s_lshl_b32 s52, s3, 10
  s_add_u32 s101, s101, s52
  s_add_u32 s101, s101, 21102592
  v_and_b32 v11, 7, v1
  v_lshlrev_b32 v11, 7, v11
  v_mov_b32 v6, 2816
  s_nop 2
gw_101:
  ds_read_b32 v7, v6
  s_waitcnt lgkmcnt(0)
  v_readfirstlane_b32 s52, v7
  s_nop 1
  s_cmp_ge_u32 s52, 4
  s_nop 1
  s_cbranch_scc1 gwok_102
  s_sleep 1
  s_add_u32 s95, s95, 1
  s_cmp_gt_u32 s95, 1000000
  s_cbranch_scc0 gw_101
gwok_102:
  buffer_load_dword v11, v11, s[32:35], s101 offen sc1
  ds_read_b128 v[76:79], v8 offset:0
  ds_read_b128 v[80:83], v8 offset:256
  ds_read_b128 v[84:87], v8 offset:10240
  ds_read_b128 v[88:91], v8 offset:10496
  ds_read_b128 v[92:95], v8 offset:20480
  ds_read_b128 v[96:99], v8 offset:20736
  ds_read_b128 v[100:103], v8 offset:30720
  ds_read_b128 v[104:107], v8 offset:30976
  s_waitcnt lgkmcnt(0)
  v_add_f32 v76, v76, v84
  v_add_f32 v92, v92, v100
  v_add_f32 v68, v76, v92
  v_add_f32 v77, v77, v85
  v_add_f32 v93, v93, v101
  v_add_f32 v69, v77, v93
  v_add_f32 v78, v78, v86
  v_add_f32 v94, v94, v102
  v_add_f32 v70, v78, v94
  v_add_f32 v79, v79, v87
  v_add_f32 v95, v95, v103
  v_add_f32 v71, v79, v95
  v_add_f32 v80, v80, v88
  v_add_f32 v96, v96, v104
  v_add_f32 v72, v80, v96
  v_add_f32 v81, v81, v89
  v_add_f32 v97, v97, v105
  v_add_f32 v73, v81, v97
  v_add_f32 v82, v82, v90
  v_add_f32 v98, v98, v106
  v_add_f32 v74, v82, v98
  v_add_f32 v83, v83, v91
  v_add_f32 v99, v99, v107
  v_add_f32 v75, v83, v99
  v_lshlrev_b32 v6, 16, v12
  v_add_f32 v68, v68, v6
  v_and_b32 v6, 0xffff0000, v12
  v_add_f32 v69, v69, v6
  v_lshlrev_b32 v6, 16, v13
  v_add_f32 v70, v70, v6
  v_and_b32 v6, 0xffff0000, v13
  v_add_f32 v71, v71, v6
  v_lshlrev_b32 v6, 16, v14
  v_add_f32 v72, v72, v6
  v_and_b32 v6, 0xffff0000, v14
  v_add_f32 v73, v73, v6
  v_lshlrev_b32 v6, 16, v15
  v_add_f32 v74, v74, v6
  v_and_b32 v6, 0xffff0000, v15
  v_add_f32 v75, v75, v6
  v_cvt_pk_bf16_f32 v28, v68, v69
  v_cvt_pk_bf16_f32 v29, v70, v71
  v_cvt_pk_bf16_f32 v30, v72, v73
  v_cvt_pk_bf16_f32 v31, v74, v75
  buffer_store_dwordx4 v[28:31], v2, s[32:35], s67 offen sc1
  v_add_f32 v32, v68, v69
  v_mul_f32 v33, v68, v68
  v_mul_f32 v35, v69, v69
  v_add_f32 v34, v70, v71
  v_fmac_f32 v35, v70, v70
  v_fmac_f32 v33, v71, v71
  v_fmac_f32 v35, v72, v72
  v_fmac_f32 v33, v73, v73
  v_fmac_f32 v35, v74, v74
  v_fmac_f32 v33, v75, v75
  v_add_f32 v34, v34, v72
  v_add_f32 v32, v32, v73
  v_add_f32 v34, v34, v74
  v_add_f32 v32, v32, v75
  s_cmp_lg_u32 s3, 0
  s_nop 1
  s_cbranch_scc1 fin4_103
  ds_read_b128 v[76:79], v8 offset:4096
  ds_read_b128 v[80:83], v8 offset:4352
  ds_read_b128 v[84:87], v8 offset:14336
  ds_read_b128 v[88:91], v8 offset:14592
  ds_read_b128 v[92:95], v8 offset:24576
  ds_read_b128 v[96:99], v8 offset:24832
  ds_read_b128 v[100:103], v8 offset:34816
  ds_read_b128 v[104:107], v8 offset:35072
  s_waitcnt lgkmcnt(0)
  v_add_f32 v76, v76, v84
  v_add_f32 v92, v92, v100
  v_add_f32 v68, v76, v92
  v_add_f32 v77, v77, v85
  v_add_f32 v93, v93, v101
  v_add_f32 v69, v77, v93
  v_add_f32 v78, v78, v86
  v_add_f32 v94, v94, v102
  v_add_f32 v70, v78, v94
  v_add_f32 v79, v79, v87
  v_add_f32 v95, v95, v103
  v_add_f32 v71, v79, v95
  v_add_f32 v80, v80, v88
  v_add_f32 v96, v96, v104
  v_add_f32 v72, v80, v96
  v_add_f32 v81, v81, v89
  v_add_f32 v97, v97, v105
  v_add_f32 v73, v81, v97
  v_add_f32 v82, v82, v90
  v_add_f32 v98, v98, v106
  v_add_f32 v74, v82, v98
  v_add_f32 v83, v83, v91
  v_add_f32 v99, v99, v107
  v_add_f32 v75, v83, v99
  v_lshlrev_b32 v6, 16, v16
  v_add_f32 v68, v68, v6
  v_and_b32 v6, 0xffff0000, v16
  v_add_f32 v69, v69, v6
  v_lshlrev_b32 v6, 16, v17
  v_add_f32 v70, v70, v6
  v_and_b32 v6, 0xffff0000, v17
  v_add_f32 v71, v71, v6
  v_lshlrev_b32 v6, 16, v18
  v_add_f32 v72, v72, v6
  v_and_b32 v6, 0xffff0000, v18
  v_add_f32 v73, v73, v6
  v_lshlrev_b32 v6, 16, v19
  v_add_f32 v74, v74, v6
  v_and_b32 v6, 0xffff0000, v19
  v_add_f32 v75, v75, v6
  v_cvt_pk_bf16_f32 v28, v68, v69
  v_cvt_pk_bf16_f32 v29, v70, v71
  v_cvt_pk_bf16_f32 v30, v72, v73
  v_cvt_pk_bf16_f32 v31, v74, v75
  s_add_u32 s52, s67, 4096
  buffer_store_dwordx4 v[28:31], v2, s[32:35], s52 offen sc1
  v_fmac_f32 v35, v68, v68
  v_add_f32 v34, v34, v68
  v_fmac_f32 v33, v69, v69
  v_add_f32 v32, v32, v69
  v_fmac_f32 v35, v70, v70
  v_add_f32 v34, v34, v70
  v_fmac_f32 v33, v71, v71
  v_add_f32 v32, v32, v71
  v_fmac_f32 v35, v72, v72
  v_add_f32 v34, v34, v72
  v_fmac_f32 v33, v73, v73
  v_add_f32 v32, v32, v73
  v_fmac_f32 v35, v74, v74
  v_add_f32 v34, v34, v74
  v_fmac_f32 v33, v75, v75
  v_add_f32 v32, v32, v75
  s_nop 2
fin4_103:
  v_add_f32 v32, v32, v34
  v_add_f32 v33, v33, v35
  v_mov_b32 v34, v32
  v_mov_b32 v35, v33
  s_nop 0
  v_permlane32_swap_b32 v32, v34
  v_permlane32_swap_b32 v33, v35
  v_add_f32 v32, v32, v34
  v_add_f32 v33, v33, v35
  v_and_b32 v10, 31, v1
  v_lshlrev_b32 v10, 3, v10
  s_lshr_b32 s52, s58, 2
  s_add_u32 s52, s52, 0
  v_add_u32 v34, s52, v10
  ds_write_b64 v34, v[32:33]
  s_waitcnt lgkmcnt(0)
  v_mov_b32 v6, 2816
  v_mov_b32 v7, 1
  s_mov_b64 exec, 1
  ds_add_u32 v6, v7
  s_mov_b64 exec, -1
  s_lshl_b32 s52, s86, 10
  s_lshl_b32 s53, s87, 7
  s_add_u32 s52, s52, s53
  s_add_u32 s52, s52, 21495808
  s_mov_b32 s54, s52
  s_waitcnt vmcnt(1)
  v_cmp_eq_u32 vcc, 0, v11
  s_nop 4
  s_cbranch_vccnz slow_104
  s_add_u32 s100, s61, s72
  buffer_load_dwordx4 v[108:111], v2, s[32:35], s100 offen offset:0 sc1
  s_add_u32 s100, s61, s72
  s_add_u32 s100, s100, 20480
  buffer_load_dwordx4 v[112:115], v2, s[32:35], s100 offen offset:0 sc1
  s_add_u32 s100, s61, s72
  buffer_load_dwordx4 v[116:119], v2, s[32:35], s100 offen offset:1024 sc1
  s_add_u32 s100, s61, s72
  s_add_u32 s100, s100, 20480
  buffer_load_dwordx4 v[120:123], v2, s[32:35], s100 offen offset:1024 sc1
  s_add_u32 s100, s61, s72
  buffer_load_dwordx4 v[124:127], v2, s[32:35], s100 offen offset:2048 sc1
  s_add_u32 s100, s61, s72
  s_add_u32 s100, s100, 20480
  buffer_load_dwordx4 v[128:131], v2, s[32:35], s100 offen offset:2048 sc1
  s_add_u32 s100, s61, s72
  buffer_load_dwordx4 v[132:135], v2, s[32:35], s100 offen offset:3072 sc1
  s_add_u32 s100, s61, s72
  s_add_u32 s100, s100, 20480
  buffer_load_dwordx4 v[136:139], v2, s[32:35], s100 offen offset:3072 sc1
  s_add_u32 s100, s61, s73
  buffer_load_dwordx2 v[140:141], v3, s[32:35], s100 offen offset:0 sc1
  buffer_load_dwordx2 v[142:143], v3, s[32:35], s100 offen offset:128 sc1
  s_add_u32 s100, s61, s73
  s_add_u32 s100, s100, 20480
  buffer_load_dwordx2 v[144:145], v3, s[32:35], s100 offen offset:0 sc1
  buffer_load_dwordx2 v[146:147], v3, s[32:35], s100 offen offset:128 sc1
  s_waitcnt vmcnt(12)
  v_mov_b32 v6, 2832
  v_mov_b32 v7, 1
  s_mov_b64 exec, 1
  ds_add_rtn_u32 v6, v6, v7
  s_waitcnt lgkmcnt(0)
  v_readfirstlane_b32 s53, v6
  s_nop 1
  s_cmp_lg_u32 s53, 3
  s_nop 1
  s_cbranch_scc1 sl_106
  buffer_store_dword v7, off, s[32:35], s54 sc1
sl_106:
  s_mov_b64 exec, -1
  s_nop 0
  s_branch fj_105
slow_104:
  s_waitcnt vmcnt(0)
  v_mov_b32 v6, 2832
  v_mov_b32 v7, 1
  s_mov_b64 exec, 1
  ds_add_rtn_u32 v6, v6, v7
  s_waitcnt lgkmcnt(0)
  v_readfirstlane_b32 s53, v6
  s_nop 1
  s_cmp_lg_u32 s53, 3
  s_nop 1
  s_cbranch_scc1 sl_107
  buffer_store_dword v7, off, s[32:35], s54 sc1
sl_107:
  s_mov_b64 exec, -1
  s_lshl_b32 s101, s86, 12
  s_lshl_b32 s52, s3, 10
  s_add_u32 s101, s101, s52
  s_add_u32 s101, s101, 21102592
  v_and_b32 v6, 7, v1
  v_lshlrev_b32 v6, 7, v6
  s_nop 2
prb_108:
  buffer_load_dword v7, v6, s[32:35], s101 offen sc1
  s_waitcnt vmcnt(0)
  v_cmp_eq_u32 vcc, 0, v7
  s_nop 4
  s_cbranch_vccz prbok_109
  s_sleep 8
  s_add_u32 s95, s95, 1
  s_cmp_gt_u32 s95, 20000
  s_cbranch_scc0 prb_108
prbok_109:
  s_add_u32 s100, s61, s72
  buffer_load_dwordx4 v[108:111], v2, s[32:35], s100 offen offset:0 sc1
  s_add_u32 s100, s61, s72
  s_add_u32 s100, s100, 20480
  buffer_load_dwordx4 v[112:115], v2, s[32:35], s100 offen offset:0 sc1
  s_add_u32 s100, s61, s72
  buffer_load_dwordx4 v[116:119], v2, s[32:35], s100 offen offset:1024 sc1
  s_add_u32 s100, s61, s72
  s_add_u32 s100, s100, 20480
  buffer_load_dwordx4 v[120:123], v2, s[32:35], s100 offen offset:1024 sc1
  s_add_u32 s100, s61, s72
  buffer_load_dwordx4 v[124:127], v2, s[32:35], s100 offen offset:2048 sc1
  s_add_u32 s100, s61, s72
  s_add_u32 s100, s100, 20480
  buffer_load_dwordx4 v[128:131], v2, s[32:35], s100 offen offset:2048 sc1
  s_add_u32 s100, s61, s72
  buffer_load_dwordx4 v[132:135], v2, s[32:35], s100 offen offset:3072 sc1
  s_add_u32 s100, s61, s72
  s_add_u32 s100, s100, 20480
  buffer_load_dwordx4 v[136:139], v2, s[32:35], s100 offen offset:3072 sc1
  s_add_u32 s100, s61, s73
  buffer_load_dwordx2 v[140:141], v3, s[32:35], s100 offen offset:0 sc1
  buffer_load_dwordx2 v[142:143], v3, s[32:35], s100 offen offset:128 sc1
  s_add_u32 s100, s61, s73
  s_add_u32 s100, s100, 20480
  buffer_load_dwordx2 v[144:145], v3, s[32:35], s100 offen offset:0 sc1
  buffer_load_dwordx2 v[146:147], v3, s[32:35], s100 offen offset:128 sc1
fj_105:
s3v_110:
  s_waitcnt vmcnt(10)
  v_mfma_f32_16x16x32_bf16 v[28:31], v[156:159], v[108:111], 0
  v_mfma_f32_16x16x32_bf16 v[32:35], v[160:163], v[108:111], 0
  v_mfma_f32_16x16x32_bf16 v[36:39], v[164:167], v[108:111], 0
  v_mfma_f32_16x16x32_bf16 v[40:43], v[168:171], v[108:111], 0
  v_mfma_f32_16x16x32_bf16 v[44:47], v[172:175], v[108:111], 0
  v_mfma_f32_16x16x32_bf16 v[48:51], v[156:159], v[112:115], 0
  v_mfma_f32_16x16x32_bf16 v[52:55], v[160:163], v[112:115], 0
  v_mfma_f32_16x16x32_bf16 v[56:59], v[164:167], v[112:115], 0
  v_mfma_f32_16x16x32_bf16 v[60:63], v[168:171], v[112:115], 0
  v_mfma_f32_16x16x32_bf16 v[64:67], v[172:175], v[112:115], 0
  s_waitcnt vmcnt(8)
  v_mfma_f32_16x16x32_bf16 v[28:31], v[176:179], v[116:119], v[28:31]
  v_mfma_f32_16x16x32_bf16 v[32:35], v[180:183], v[116:119], v[32:35]
  v_mfma_f32_16x16x32_bf16 v[36:39], v[184:187], v[116:119], v[36:39]
  v_mfma_f32_16x16x32_bf16 v[40:43], v[188:191], v[116:119], v[40:43]
  v_mfma_f32_16x16x32_bf16 v[44:47], v[192:195], v[116:119], v[44:47]
  v_mfma_f32_16x16x32_bf16 v[48:51], v[176:179], v[120:123], v[48:51]
  v_mfma_f32_16x16x32_bf16 v[52:55], v[180:183], v[120:123], v[52:55]
  v_mfma_f32_16x16x32_bf16 v[56:59], v[184:187], v[120:123], v[56:59]
  v_mfma_f32_16x16x32_bf16 v[60:63], v[188:191], v[120:123], v[60:63]
  v_mfma_f32_16x16x32_bf16 v[64:67], v[192:195], v[120:123], v[64:67]
  s_waitcnt vmcnt(6)
  v_mfma_f32_16x16x32_bf16 v[28:31], v[196:199], v[124:127], v[28:31]
  v_mfma_f32_16x16x32_bf16 v[32:35], v[200:203], v[124:127], v[32:35]
  v_mfma_f32_16x16x32_bf16 v[36:39], v[204:207], v[124:127], v[36:39]
  v_mfma_f32_16x16x32_bf16 v[40:43], v[208:211], v[124:127], v[40:43]
  v_mfma_f32_16x16x32_bf16 v[44:47], v[212:215], v[124:127], v[44:47]
  v_mfma_f32_16x16x32_bf16 v[48:51], v[196:199], v[128:131], v[48:51]
  v_mfma_f32_16x16x32_bf16 v[52:55], v[200:203], v[128:131], v[52:55]
  v_mfma_f32_16x16x32_bf16 v[56:59], v[204:207], v[128:131], v[56:59]
  v_mfma_f32_16x16x32_bf16 v[60:63], v[208:211], v[128:131], v[60:63]
  v_mfma_f32_16x16x32_bf16 v[64:67], v[212:215], v[128:131], v[64:67]
  s_waitcnt vmcnt(4)
  v_mfma_f32_16x16x32_bf16 v[28:31], v[216:219], v[132:135], v[28:31]
  v_mfma_f32_16x16x32_bf16 v[32:35], v[220:223], v[132:135], v[32:35]
  v_mfma_f32_16x16x32_bf16 v[36:39], v[224:227], v[132:135], v[36:39]
  v_mfma_f32_16x16x32_bf16 v[40:43], v[228:231], v[132:135], v[40:43]
  v_mfma_f32_16x16x32_bf16 v[44:47], v[232:235], v[132:135], v[44:47]
  v_mfma_f32_16x16x32_bf16 v[48:51], v[216:219], v[136:139], v[48:51]
  v_mfma_f32_16x16x32_bf16 v[52:55], v[220:223], v[136:139], v[52:55]
  v_mfma_f32_16x16x32_bf16 v[56:59], v[224:227], v[136:139], v[56:59]
  v_mfma_f32_16x16x32_bf16 v[60:63], v[228:231], v[136:139], v[60:63]
  v_mfma_f32_16x16x32_bf16 v[64:67], v[232:235], v[136:139], v[64:67]
  s_waitcnt vmcnt(0)
  v_mfma_f32_16x16x32_bf16 v[28:31], v[236:239], v[140:143], v[28:31]
  v_mfma_f32_16x16x32_bf16 v[32:35], v[240:243], v[140:143], v[32:35]
  v_mfma_f32_16x16x32_bf16 v[36:39], v[244:247], v[140:143], v[36:39]
  v_mfma_f32_16x16x32_bf16 v[40:43], v[248:251], v[140:143], v[40:43]
  v_mfma_f32_16x16x32_bf16 v[44:47], v[252:255], v[140:143], v[44:47]
  v_mfma_f32_16x16x32_bf16 v[48:51], v[236:239], v[144:147], v[48:51]
  v_mfma_f32_16x16x32_bf16 v[52:55], v[240:243], v[144:147], v[52:55]
  v_mfma_f32_16x16x32_bf16 v[56:59], v[244:247], v[144:147], v[56:59]
  v_mfma_f32_16x16x32_bf16 v[60:63], v[248:251], v[144:147], v[60:63]
  v_mfma_f32_16x16x32_bf16 v[64:67], v[252:255], v[144:147], v[64:67]
  v_mov_b32 v6, 2816
  s_nop 6
gw_111:
  ds_read_b32 v7, v6
  s_waitcnt lgkmcnt(0)
  v_readfirstlane_b32 s52, v7
  s_nop 1
  s_cmp_ge_u32 s52, 8
  s_nop 1
  s_cbranch_scc1 gwok_112
  s_sleep 1
  s_add_u32 s95, s95, 1
  s_cmp_gt_u32 s95, 1000000
  s_cbranch_scc0 gw_111
gwok_112:
  ds_write_b128 v4, v[28:31] offset:0
  ds_write_b128 v4, v[32:35] offset:1024
  ds_write_b128 v4, v[36:39] offset:2048
  ds_write_b128 v4, v[40:43] offset:3072
  ds_write_b128 v4, v[44:47] offset:4096
  ds_write_b128 v4, v[48:51] offset:5120
  ds_write_b128 v4, v[52:55] offset:6144
  ds_write_b128 v4, v[56:59] offset:7168
  ds_write_b128 v4, v[60:63] offset:8192
  ds_write_b128 v4, v[64:67] offset:9216
  s_waitcnt lgkmcnt(0)
  v_mov_b32 v6, 2816
  v_mov_b32 v7, 1
  s_mov_b64 exec, 1
  ds_add_u32 v6, v7
  s_mov_b64 exec, -1
  v_mov_b32 v6, 2816
  s_nop 2
gw_113:
  ds_read_b32 v7, v6
  s_waitcnt lgkmcnt(0)
  v_readfirstlane_b32 s52, v7
  s_nop 1
  s_cmp_ge_u32 s52, 12
  s_nop 1
  s_cbranch_scc1 gwok_114
  s_sleep 1
  s_add_u32 s95, s95, 1
  s_cmp_gt_u32 s95, 1000000
  s_cbranch_scc0 gw_113
gwok_114:
  ds_read_b128 v[76:79], v8 offset:0
  ds_read_b128 v[80:83], v8 offset:256
  ds_read_b128 v[84:87], v8 offset:10240
  ds_read_b128 v[88:91], v8 offset:10496
  ds_read_b128 v[92:95], v8 offset:20480
  ds_read_b128 v[96:99], v8 offset:20736
  ds_read_b128 v[100:103], v8 offset:30720
  ds_read_b128 v[104:107], v8 offset:30976
  s_waitcnt lgkmcnt(0)
  v_add_f32 v76, v76, v84
  v_add_f32 v92, v92, v100
  v_add_f32 v68, v76, v92
  v_add_f32 v77, v77, v85
  v_add_f32 v93, v93, v101
  v_add_f32 v69, v77, v93
  v_add_f32 v78, v78, v86
  v_add_f32 v94, v94, v102
  v_add_f32 v70, v78, v94
  v_add_f32 v79, v79, v87
  v_add_f32 v95, v95, v103
  v_add_f32 v71, v79, v95
  v_add_f32 v80, v80, v88
  v_add_f32 v96, v96, v104
  v_add_f32 v72, v80, v96
  v_add_f32 v81, v81, v89
  v_add_f32 v97, v97, v105
  v_add_f32 v73, v81, v97
  v_add_f32 v82, v82, v90
  v_add_f32 v98, v98, v106
  v_add_f32 v74, v82, v98
  v_add_f32 v83, v83, v91
  v_add_f32 v99, v99, v107
  v_add_f32 v75, v83, v99
  v_lshlrev_b32 v6, 16, v20
  v_add_f32 v68, v68, v6
  v_and_b32 v6, 0xffff0000, v20
  v_add_f32 v69, v69, v6
  v_lshlrev_b32 v6, 16, v21
  v_add_f32 v70, v70, v6
  v_and_b32 v6, 0xffff0000, v21
  v_add_f32 v71, v71, v6
  v_lshlrev_b32 v6, 16, v22
  v_add_f32 v72, v72, v6
  v_and_b32 v6, 0xffff0000, v22
  v_add_f32 v73, v73, v6
  v_lshlrev_b32 v6, 16, v23
  v_add_f32 v74, v74, v6
  v_and_b32 v6, 0xffff0000, v23
  v_add_f32 v75, v75, v6
  v_cvt_pk_bf16_f32 v28, v68, v69
  v_cvt_pk_bf16_f32 v29, v70, v71
  v_cvt_pk_bf16_f32 v30, v72, v73
  v_cvt_pk_bf16_f32 v31, v74, v75
  buffer_store_dwordx4 v[28:31], v2, s[32:35], s68 offen sc1
  v_add_f32 v32, v68, v69
  v_mul_f32 v33, v68, v68
  v_mul_f32 v35, v69, v69
  v_add_f32 v34, v70, v71
  v_fmac_f32 v35, v70, v70
  v_fmac_f32 v33, v71, v71
  v_fmac_f32 v35, v72, v72
  v_fmac_f32 v33, v73, v73
  v_fmac_f32 v35, v74, v74
  v_fmac_f32 v33, v75, v75
  v_add_f32 v34, v34, v72
  v_add_f32 v32, v32, v73
  v_add_f32 v34, v34, v74
  v_add_f32 v32, v32, v75
  s_cmp_lg_u32 s3, 0
  s_nop 1
  s_cbranch_scc1 fin4_115
  ds_read_b128 v[76:79], v8 offset:4096
  ds_read_b128 v[80:83], v8 offset:4352
  ds_read_b128 v[84:87], v8 offset:14336
  ds_read_b128 v[88:91], v8 offset:14592
  ds_read_b128 v[92:95], v8 offset:24576
  ds_read_b128 v[96:99], v8 offset:24832
  ds_read_b128 v[100:103], v8 offset:34816
  ds_read_b128 v[104:107], v8 offset:35072
  s_waitcnt lgkmcnt(0)
  v_add_f32 v76, v76, v84
  v_add_f32 v92, v92, v100
  v_add_f32 v68, v76, v92
  v_add_f32 v77, v77, v85
  v_add_f32 v93, v93, v101
  v_add_f32 v69, v77, v93
  v_add_f32 v78, v78, v86
  v_add_f32 v94, v94, v102
  v_add_f32 v70, v78, v94
  v_add_f32 v79, v79, v87
  v_add_f32 v95, v95, v103
  v_add_f32 v71, v79, v95
  v_add_f32 v80, v80, v88
  v_add_f32 v96, v96, v104
  v_add_f32 v72, v80, v96
  v_add_f32 v81, v81, v89
  v_add_f32 v97, v97, v105
  v_add_f32 v73, v81, v97
  v_add_f32 v82, v82, v90
  v_add_f32 v98, v98, v106
  v_add_f32 v74, v82, v98
  v_add_f32 v83, v83, v91
  v_add_f32 v99, v99, v107
  v_add_f32 v75, v83, v99
  v_lshlrev_b32 v6, 16, v24
  v_add_f32 v68, v68, v6
  v_and_b32 v6, 0xffff0000, v24
  v_add_f32 v69, v69, v6
  v_lshlrev_b32 v6, 16, v25
  v_add_f32 v70, v70, v6
  v_and_b32 v6, 0xffff0000, v25
  v_add_f32 v71, v71, v6
  v_lshlrev_b32 v6, 16, v26
  v_add_f32 v72, v72, v6
  v_and_b32 v6, 0xffff0000, v26
  v_add_f32 v73, v73, v6
  v_lshlrev_b32 v6, 16, v27
  v_add_f32 v74, v74, v6
  v_and_b32 v6, 0xffff0000, v27
  v_add_f32 v75, v75, v6
  v_cvt_pk_bf16_f32 v28, v68, v69
  v_cvt_pk_bf16_f32 v29, v70, v71
  v_cvt_pk_bf16_f32 v30, v72, v73
  v_cvt_pk_bf16_f32 v31, v74, v75
  s_add_u32 s52, s68, 4096
  buffer_store_dwordx4 v[28:31], v2, s[32:35], s52 offen sc1
  v_fmac_f32 v35, v68, v68
  v_add_f32 v34, v34, v68
  v_fmac_f32 v33, v69, v69
  v_add_f32 v32, v32, v69
  v_fmac_f32 v35, v70, v70
  v_add_f32 v34, v34, v70
  v_fmac_f32 v33, v71, v71
  v_add_f32 v32, v32, v71
  v_fmac_f32 v35, v72, v72
  v_add_f32 v34, v34, v72
  v_fmac_f32 v33, v73, v73
  v_add_f32 v32, v32, v73
  v_fmac_f32 v35, v74, v74
  v_add_f32 v34, v34, v74
  v_fmac_f32 v33, v75, v75
  v_add_f32 v32, v32, v75
  s_nop 2
fin4_115:
  v_add_f32 v32, v32, v34
  v_add_f32 v33, v33, v35
  v_mov_b32 v34, v32
  v_mov_b32 v35, v33
  s_nop 0
  v_permlane32_swap_b32 v32, v34
  v_permlane32_swap_b32 v33, v35
  v_add_f32 v32, v32, v34
  v_add_f32 v33, v33, v35
  v_and_b32 v10, 31, v1
  v_lshlrev_b32 v10, 3, v10
  s_lshr_b32 s52, s58, 2
  s_add_u32 s52, s52, 1024
  v_add_u32 v34, s52, v10
  ds_write_b64 v34, v[32:33]
  s_waitcnt lgkmcnt(0)
  v_mov_b32 v6, 2816
  v_mov_b32 v7, 1
  s_mov_b64 exec, 1
  ds_add_u32 v6, v7
  s_mov_b64 exec, -1
  s_lshl_b32 s52, s86, 10
  s_lshl_b32 s53, s87, 7
  s_add_u32 s52, s52, s53
  s_add_u32 s52, s52, 21528576
  s_waitcnt vmcnt(0)
  v_mov_b32 v6, 2836
  v_mov_b32 v7, 1
  s_mov_b64 exec, 1
  ds_add_rtn_u32 v6, v6, v7
  s_waitcnt lgkmcnt(0)
  v_readfirstlane_b32 s53, v6
  s_nop 1
  s_cmp_lg_u32 s53, 3
  s_nop 1
  s_cbranch_scc1 sl_116
  buffer_store_dword v7, off, s[32:35], s52 sc1
sl_116:
  s_mov_b64 exec, -1
  v_mov_b32 v6, 2816
  s_nop 2
gw_117:
  ds_read_b32 v7, v6
  s_waitcnt lgkmcnt(0)
  v_readfirstlane_b32 s52, v7
  s_nop 1
  s_cmp_ge_u32 s52, 16
  s_nop 1
  s_cbranch_scc1 gwok_118
  s_sleep 1
  s_add_u32 s95, s95, 1
  s_cmp_gt_u32 s95, 1000000
  s_cbranch_scc0 gw_117
gwok_118:
  s_cmp_lg_u32 s3, 2
  s_cbranch_scc1 hst_119
  v_add_u32 v11, 0, v10
  ds_read_b64 v[148:149], v11 offset:0
  ds_read_b64 v[150:151], v11 offset:256
  ds_read_b64 v[152:153], v11 offset:512
  ds_read_b64 v[154:155], v11 offset:768
  s_waitcnt lgkmcnt(0)
  v_add_f32 v148, v148, v150
  v_add_f32 v149, v149, v151
  v_add_f32 v148, v148, v152
  v_add_f32 v149, v149, v153
  v_add_f32 v148, v148, v154
  v_add_f32 v149, v149, v155
  s_lshl_b32 s52, s86, 11
  s_lshl_b32 s53, s87, 8
  s_add_u32 s52, s52, s53
  s_add_u32 s52, s52, 19922944
  s_mov_b32 exec_hi, 0
  buffer_store_dwordx2 v[148:149], v10, s[32:35], s52 offen sc1
  s_mov_b64 exec, -1
  s_lshl_b32 s52, s86, 10
  s_lshl_b32 s53, s87, 7
  s_add_u32 s52, s52, s53
  s_add_u32 s52, s52, 21561344
  s_waitcnt vmcnt(0)
  v_mov_b32 v148, 1
  s_mov_b64 exec, 1
  buffer_store_dword v148, off, s[32:35], s52 sc1
  s_mov_b64 exec, -1
  s_nop 0
hst_119:
  s_cmp_lg_u32 s3, 3
  s_cbranch_scc1 hst_120
  v_add_u32 v11, 1024, v10
  ds_read_b64 v[148:149], v11 offset:0
  ds_read_b64 v[150:151], v11 offset:256
  ds_read_b64 v[152:153], v11 offset:512
  ds_read_b64 v[154:155], v11 offset:768
  s_waitcnt lgkmcnt(0)
  v_add_f32 v148, v148, v150
  v_add_f32 v149, v149, v151
  v_add_f32 v148, v148, v152
  v_add_f32 v149, v149, v153
  v_add_f32 v148, v148, v154
  v_add_f32 v149, v149, v155
  s_lshl_b32 s52, s86, 11
  s_lshl_b32 s53, s87, 8
  s_add_u32 s52, s52, s53
  s_add_u32 s52, s52, 19988480
  s_mov_b32 exec_hi, 0
  buffer_store_dwordx2 v[148:149], v10, s[32:35], s52 offen sc1
  s_mov_b64 exec, -1
  s_lshl_b32 s52, s86, 10
  s_lshl_b32 s53, s87, 7
  s_add_u32 s52, s52, s53
  s_add_u32 s52, s52, 21594112
  s_waitcnt vmcnt(0)
  v_mov_b32 v148, 1
  s_mov_b64 exec, 1
  buffer_store_dword v148, off, s[32:35], s52 sc1
  s_mov_b64 exec, -1
  s_nop 0
hst_120:
  buffer_load_dwordx4 v[168:171], v2, s[32:35], s59 offen offset:0 sc1
  buffer_load_dwordx4 v[172:175], v2, s[32:35], s59 offen offset:1024 sc1
  buffer_load_dwordx4 v[176:179], v2, s[32:35], s59 offen offset:2048 sc1
  buffer_load_dwordx4 v[180:183], v2, s[32:35], s59 offen offset:3072 sc1
  s_add_u32 s100, s59, 4096
  buffer_load_dwordx4 v[184:187], v2, s[32:35], s100 offen offset:0 sc1
  s_add_u32 s100, s59, 4096
  buffer_load_dwordx4 v[188:191], v2, s[32:35], s100 offen offset:1024 sc1
  s_add_u32 s100, s59, 4096
  buffer_load_dwordx4 v[192:195], v2, s[32:35], s100 offen offset:2048 sc1
  s_add_u32 s100, s59, 4096
  buffer_load_dwordx4 v[196:199], v2, s[32:35], s100 offen offset:3072 sc1
  s_add_u32 s100, s59, 8192
  buffer_load_dwordx4 v[200:203], v2, s[32:35], s100 offen offset:0 sc1
  s_add_u32 s100, s59, 8192
  buffer_load_dwordx4 v[204:207], v2, s[32:35], s100 offen offset:1024 sc1
  s_add_u32 s100, s59, 8192
  buffer_load_dwordx4 v[208:211], v2, s[32:35], s100 offen offset:2048 sc1
  s_add_u32 s100, s59, 8192
  buffer_load_dwordx4 v[212:215], v2, s[32:35], s100 offen offset:3072 sc1
  s_add_u32 s100, s59, 12288
  buffer_load_dwordx4 v[216:219], v2, s[32:35], s100 offen offset:0 sc1
  s_add_u32 s100, s59, 12288
  buffer_load_dwordx4 v[220:223], v2, s[32:35], s100 offen offset:1024 sc1
  s_add_u32 s100, s59, 12288
  buffer_load_dwordx4 v[224:227], v2, s[32:35], s100 offen offset:2048 sc1
  s_add_u32 s100, s59, 12288
  buffer_load_dwordx4 v[228:231], v2, s[32:35], s100 offen offset:3072 sc1
  s_add_u32 s100, s59, 16384
  buffer_load_dwordx4 v[232:235], v2, s[32:35], s100 offen offset:0 sc1
  s_add_u32 s100, s59, 16384
  buffer_load_dwordx4 v[236:239], v2, s[32:35], s100 offen offset:1024 sc1
  s_add_u32 s100, s59, 16384
  buffer_load_dwordx4 v[240:243], v2, s[32:35], s100 offen offset:2048 sc1
  s_add_u32 s100, s59, 16384
  buffer_load_dwordx4 v[244:247], v2, s[32:35], s100 offen offset:3072 sc1
  s_add_u32 s100, s59, 20480
  buffer_load_dwordx4 v[248:251], v2, s[32:35], s100 offen offset:0 sc1
  s_add_u32 s100, s59, 20480
  buffer_load_dwordx4 v[252:255], v2, s[32:35], s100 offen offset:1024 sc1
  v_mov_b32 v6, 2820
  s_nop 2
gw_121:
  ds_read_b32 v7, v6
  s_waitcnt lgkmcnt(0)
  v_readfirstlane_b32 s52, v7
  s_nop 1
  s_cmp_ge_u32 s52, 12
  s_nop 1
  s_cbranch_scc1 gwok_122
  s_sleep 1
  s_add_u32 s95, s95, 1
  s_cmp_gt_u32 s95, 1000000
  s_cbranch_scc0 gw_121
gwok_122:
  s_setprio 0
  v_add_u32 v4, 61440, v2
  v_lshrrev_b32 v8, 5, v1
  v_lshlrev_b32 v8, 4, v8
  v_add_u32 v6, 2048, v8
  v_lshrrev_b32 v8, 4, v1
  v_and_b32 v9, 15, v1
  v_lshlrev_b32 v8, 9, v8
  v_lshl_add_u32 v7, v9, 4, v8
  s_mov_b32 s78, 0xc0135761
  s_mov_b32 s79, 0xbdd2d3e8
  s_sub_u32 s52, s57, s58
  buffer_load_dwordx4 v[64:67], v2, s[32:35], s52 offen offset:0 sc1
  buffer_load_dwordx4 v[68:71], v2, s[32:35], s52 offen offset:1024 sc1
  buffer_load_dwordx4 v[72:75], v2, s[32:35], s52 offen offset:2048 sc1
  s_lshl_b32 s101, s90, 10
  s_add_u32 s101, s101, 21495808
  v_and_b32 v8, 7, v1
  v_lshlrev_b32 v8, 7, v8
  s_nop 2
prb_123:
  buffer_load_dword v9, v8, s[32:35], s101 offen sc1
  s_waitcnt vmcnt(0)
  v_cmp_eq_u32 vcc, 0, v9
  s_nop 4
  s_cbranch_vccz prbok_124
  s_sleep 8
  s_add_u32 s95, s95, 1
  s_cmp_gt_u32 s95, 20000
  s_cbranch_scc0 prb_123
prbok_124:
  buffer_load_dwordx4 v[88:91], v2, s[32:35], s62 offen offset:0 sc1
  buffer_load_dwordx4 v[92:95], v2, s[32:35], s62 offen offset:1024 sc1
  buffer_load_dwordx4 v[96:99], v2, s[32:35], s62 offen offset:2048 sc1
  buffer_load_dwordx4 v[100:103], v2, s[32:35], s62 offen offset:3072 sc1
  s_add_u32 s100, s62, 4096
  buffer_load_dwordx4 v[104:107], v2, s[32:35], s100 offen offset:0 sc1
  s_add_u32 s100, s62, 4096
  buffer_load_dwordx4 v[108:111], v2, s[32:35], s100 offen offset:1024 sc1
  s_add_u32 s100, s62, 4096
  buffer_load_dwordx4 v[112:115], v2, s[32:35], s100 offen offset:2048 sc1
  s_add_u32 s100, s62, 4096
  buffer_load_dwordx4 v[116:119], v2, s[32:35], s100 offen offset:3072 sc1
s4v_125:
  ds_read_b128 v[76:79], v2 offset:3072
  ds_read_b128 v[80:83], v2 offset:4096
  ds_read_b128 v[84:87], v2 offset:5120
  s_waitcnt vmcnt(7)
  v_mfma_f32_32x32x16_bf16 v[16:31], v[64:67], v[88:91], 0
  s_add_u32 s100, s62, 8192
  buffer_load_dwordx4 v[120:123], v2, s[32:35], s100 offen offset:0 sc1
  v_mfma_f32_32x32x16_bf16 v[32:47], v[68:71], v[88:91], 0
  s_add_u32 s100, s62, 8192
  buffer_load_dwordx4 v[124:127], v2, s[32:35], s100 offen offset:1024 sc1
  v_mfma_f32_32x32x16_bf16 v[48:63], v[72:75], v[88:91], 0
  ds_read_b128 v[64:67], v2 offset:6144
  ds_read_b128 v[68:71], v2 offset:7168
  ds_read_b128 v[72:75], v2 offset:8192
  s_waitcnt vmcnt(8)
  s_waitcnt lgkmcnt(3)
  v_mfma_f32_32x32x16_bf16 v[16:31], v[76:79], v[92:95], v[16:31]
  s_add_u32 s100, s62, 8192
  buffer_load_dwordx4 v[128:131], v2, s[32:35], s100 offen offset:2048 sc1
  v_mfma_f32_32x32x16_bf16 v[32:47], v[80:83], v[92:95], v[32:47]
  s_add_u32 s100, s62, 8192
  buffer_load_dwordx4 v[132:135], v2, s[32:35], s100 offen offset:3072 sc1
  v_mfma_f32_32x32x16_bf16 v[48:63], v[84:87], v[92:95], v[48:63]
  ds_read_b128 v[76:79], v2 offset:9216
  ds_read_b128 v[80:83], v2 offset:10240
  ds_read_b128 v[84:87], v2 offset:11264
  s_waitcnt vmcnt(9)
  s_waitcnt lgkmcnt(3)
  v_mfma_f32_32x32x16_bf16 v[16:31], v[64:67], v[96:99], v[16:31]
  s_add_u32 s100, s62, 12288
  buffer_load_dwordx4 v[136:139], v2, s[32:35], s100 offen offset:0 sc1
  v_mfma_f32_32x32x16_bf16 v[32:47], v[68:71], v[96:99], v[32:47]
  s_add_u32 s100, s62, 12288
  buffer_load_dwordx4 v[140:143], v2, s[32:35], s100 offen offset:1024 sc1
  v_mfma_f32_32x32x16_bf16 v[48:63], v[72:75], v[96:99], v[48:63]
  ds_read_b128 v[64:67], v2 offset:12288
  ds_read_b128 v[68:71], v2 offset:13312
  ds_read_b128 v[72:75], v2 offset:14336
  s_waitcnt vmcnt(10)
  s_waitcnt lgkmcnt(3)
  v_mfma_f32_32x32x16_bf16 v[16:31], v[76:79], v[100:103], v[16:31]
  s_add_u32 s100, s62, 12288
  buffer_load_dwordx4 v[144:147], v2, s[32:35], s100 offen offset:2048 sc1
  v_mfma_f32_32x32x16_bf16 v[32:47], v[80:83], v[100:103], v[32:47]
  s_add_u32 s100, s62, 12288
  buffer_load_dwordx4 v[148:151], v2, s[32:35], s100 offen offset:3072 sc1
  v_mfma_f32_32x32x16_bf16 v[48:63], v[84:87], v[100:103], v[48:63]
  ds_read_b128 v[76:79], v2 offset:15360
  ds_read_b128 v[80:83], v2 offset:16384
  ds_read_b128 v[84:87], v2 offset:17408
  s_waitcnt vmcnt(11)
  s_waitcnt lgkmcnt(3)
  v_mfma_f32_32x32x16_bf16 v[16:31], v[64:67], v[104:107], v[16:31]
  s_add_u32 s100, s62, 16384
  buffer_load_dwordx4 v[152:155], v2, s[32:35], s100 offen offset:0 sc1
  v_mfma_f32_32x32x16_bf16 v[32:47], v[68:71], v[104:107], v[32:47]
  s_add_u32 s100, s62, 16384
  buffer_load_dwordx4 v[156:159], v2, s[32:35], s100 offen offset:1024 sc1
  v_mfma_f32_32x32x16_bf16 v[48:63], v[72:75], v[104:107], v[48:63]
  ds_read_b128 v[64:67], v2 offset:18432
  ds_read_b128 v[68:71], v2 offset:19456
  ds_read_b128 v[72:75], v2 offset:20480
  s_waitcnt vmcnt(12)
  s_waitcnt lgkmcnt(3)
  v_mfma_f32_32x32x16_bf16 v[16:31], v[76:79], v[108:111], v[16:31]
  s_add_u32 s100, s62, 16384
  buffer_load_dwordx4 v[160:163], v2, s[32:35], s100 offen offset:2048 sc1
  v_mfma_f32_32x32x16_bf16 v[32:47], v[80:83], v[108:111], v[32:47]
  s_add_u32 s100, s62, 16384
  buffer_load_dwordx4 v[164:167], v2, s[32:35], s100 offen offset:3072 sc1
  v_mfma_f32_32x32x16_bf16 v[48:63], v[84:87], v[108:111], v[48:63]
  ds_read_b128 v[76:79], v2 offset:21504
  ds_read_b128 v[80:83], v2 offset:22528
  ds_read_b128 v[84:87], v2 offset:23552
  s_waitcnt vmcnt(13)
  s_waitcnt lgkmcnt(3)
  v_mfma_f32_32x32x16_bf16 v[16:31], v[64:67], v[112:115], v[16:31]
  s_add_u32 s100, s62, 20480
  buffer_load_dwordx4 v[88:91], v2, s[32:35], s100 offen offset:0 sc1
  v_mfma_f32_32x32x16_bf16 v[32:47], v[68:71], v[112:115], v[32:47]
  v_mfma_f32_32x32x16_bf16 v[48:63], v[72:75], v[112:115], v[48:63]
  ds_read_b128 v[64:67], v2 offset:24576
  ds_read_b128 v[68:71], v2 offset:25600
  ds_read_b128 v[72:75], v2 offset:26624
  s_waitcnt vmcnt(13)
  s_waitcnt lgkmcnt(3)
  v_mfma_f32_32x32x16_bf16 v[16:31], v[76:79], v[116:119], v[16:31]
  s_add_u32 s100, s62, 20480
  buffer_load_dwordx4 v[92:95], v2, s[32:35], s100 offen offset:1024 sc1
  v_mfma_f32_32x32x16_bf16 v[32:47], v[80:83], v[116:119], v[32:47]
  v_mfma_f32_32x32x16_bf16 v[48:63], v[84:87], v[116:119], v[48:63]
  ds_read_b128 v[76:79], v2 offset:27648
  ds_read_b128 v[80:83], v2 offset:28672
  ds_read_b128 v[84:87], v2 offset:29696
  s_waitcnt vmcnt(13)
  s_waitcnt lgkmcnt(3)
  v_mfma_f32_32x32x16_bf16 v[16:31], v[64:67], v[120:123], v[16:31]
  s_add_u32 s100, s62, 20480
  buffer_load_dwordx4 v[96:99], v2, s[32:35], s100 offen offset:2048 sc1
  v_mfma_f32_32x32x16_bf16 v[32:47], v[68:71], v[120:123], v[32:47]
  v_mfma_f32_32x32x16_bf16 v[48:63], v[72:75], v[120:123], v[48:63]
  ds_read_b128 v[64:67], v2 offset:30720
  ds_read_b128 v[68:71], v2 offset:31744
  ds_read_b128 v[72:75], v2 offset:32768
  s_waitcnt vmcnt(13)
  s_waitcnt lgkmcnt(3)
  v_mfma_f32_32x32x16_bf16 v[16:31], v[76:79], v[124:127], v[16:31]
  s_add_u32 s100, s62, 20480
  buffer_load_dwordx4 v[100:103], v2, s[32:35], s100 offen offset:3072 sc1
  v_mfma_f32_32x32x16_bf16 v[32:47], v[80:83], v[124:127], v[32:47]
  v_mfma_f32_32x32x16_bf16 v[48:63], v[84:87], v[124:127], v[48:63]
  ds_read_b128 v[76:79], v2 offset:33792
  ds_read_b128 v[80:83], v2 offset:34816
  ds_read_b128 v[84:87], v2 offset:35840
  s_waitcnt vmcnt(13)
  s_waitcnt lgkmcnt(3)
  v_mfma_f32_32x32x16_bf16 v[16:31], v[64:67], v[128:131], v[16:31]
  s_add_u32 s100, s62, 24576
  buffer_load_dwordx4 v[104:107], v2, s[32:35], s100 offen offset:0 sc1
  v_mfma_f32_32x32x16_bf16 v[32:47], v[68:71], v[128:131], v[32:47]
  v_mfma_f32_32x32x16_bf16 v[48:63], v[72:75], v[128:131], v[48:63]
  ds_read_b128 v[64:67], v2 offset:36864
  ds_read_b128 v[68:71], v2 offset:37888
  ds_read_b128 v[72:75], v2 offset:38912
  s_waitcnt vmcnt(13)
  s_waitcnt lgkmcnt(3)
  v_mfma_f32_32x32x16_bf16 v[16:31], v[76:79], v[132:135], v[16:31]
  s_add_u32 s100, s62, 24576
  buffer_load_dwordx4 v[108:111], v2, s[32:35], s100 offen offset:1024 sc1
  v_mfma_f32_32x32x16_bf16 v[32:47], v[80:83], v[132:135], v[32:47]
  v_mfma_f32_32x32x16_bf16 v[48:63], v[84:87], v[132:135], v[48:63]
  ds_read_b128 v[76:79], v2 offset:39936
  ds_read_b128 v[80:83], v2 offset:40960
  ds_read_b128 v[84:87], v2 offset:41984
  s_waitcnt vmcnt(13)
  s_waitcnt lgkmcnt(3)
  v_mfma_f32_32x32x16_bf16 v[16:31], v[64:67], v[136:139], v[16:31]
  s_add_u32 s100, s62, 24576
  buffer_load_dwordx4 v[112:115], v2, s[32:35], s100 offen offset:2048 sc1
  v_mfma_f32_32x32x16_bf16 v[32:47], v[68:71], v[136:139], v[32:47]
  v_mfma_f32_32x32x16_bf16 v[48:63], v[72:75], v[136:139], v[48:63]
  ds_read_b128 v[64:67], v2 offset:43008
  ds_read_b128 v[68:71], v2 offset:44032
  ds_read_b128 v[72:75], v2 offset:45056
  s_waitcnt vmcnt(13)
  s_waitcnt lgkmcnt(3)
  v_mfma_f32_32x32x16_bf16 v[16:31], v[76:79], v[140:143], v[16:31]
  s_add_u32 s100, s62, 24576
  buffer_load_dwordx4 v[116:119], v2, s[32:35], s100 offen offset:3072 sc1
  v_mfma_f32_32x32x16_bf16 v[32:47], v[80:83], v[140:143], v[32:47]
  v_mfma_f32_32x32x16_bf16 v[48:63], v[84:87], v[140:143], v[48:63]
  ds_read_b128 v[76:79], v2 offset:46080
  ds_read_b128 v[80:83], v2 offset:47104
  ds_read_b128 v[84:87], v2 offset:48128
  s_waitcnt vmcnt(13)
  s_waitcnt lgkmcnt(3)
  v_mfma_f32_32x32x16_bf16 v[16:31], v[64:67], v[144:147], v[16:31]
  s_add_u32 s100, s62, 28672
  buffer_load_dwordx4 v[120:123], v2, s[32:35], s100 offen offset:0 sc1
  v_mfma_f32_32x32x16_bf16 v[32:47], v[68:71], v[144:147], v[32:47]
  v_mfma_f32_32x32x16_bf16 v[48:63], v[72:75], v[144:147], v[48:63]
  ds_read_b128 v[64:67], v2 offset:49152
  ds_read_b128 v[68:71], v2 offset:50176
  ds_read_b128 v[72:75], v2 offset:51200
  s_waitcnt vmcnt(13)
  s_waitcnt lgkmcnt(3)
  v_mfma_f32_32x32x16_bf16 v[16:31], v[76:79], v[148:151], v[16:31]
  s_add_u32 s100, s62, 28672
  buffer_load_dwordx4 v[124:127], v2, s[32:35], s100 offen offset:1024 sc1
  v_mfma_f32_32x32x16_bf16 v[32:47], v[80:83], v[148:151], v[32:47]
  v_mfma_f32_32x32x16_bf16 v[48:63], v[84:87], v[148:151], v[48:63]
  ds_read_b128 v[76:79], v2 offset:52224
  ds_read_b128 v[80:83], v2 offset:53248
  ds_read_b128 v[84:87], v2 offset:54272
  s_waitcnt vmcnt(13)
  s_waitcnt lgkmcnt(3)
  v_mfma_f32_32x32x16_bf16 v[16:31], v[64:67], v[152:155], v[16:31]
  s_add_u32 s100, s62, 28672
  buffer_load_dwordx4 v[128:131], v2, s[32:35], s100 offen offset:2048 sc1
  v_mfma_f32_32x32x16_bf16 v[32:47], v[68:71], v[152:155], v[32:47]
  v_mfma_f32_32x32x16_bf16 v[48:63], v[72:75], v[152:155], v[48:63]
  ds_read_b128 v[64:67], v2 offset:55296
  ds_read_b128 v[68:71], v2 offset:56320
  ds_read_b128 v[72:75], v2 offset:57344
  s_waitcnt vmcnt(13)
  s_waitcnt lgkmcnt(3)
  v_mfma_f32_32x32x16_bf16 v[16:31], v[76:79], v[156:159], v[16:31]
  s_add_u32 s100, s62, 28672
  buffer_load_dwordx4 v[132:135], v2, s[32:35], s100 offen offset:3072 sc1
  v_mfma_f32_32x32x16_bf16 v[32:47], v[80:83], v[156:159], v[32:47]
  v_mfma_f32_32x32x16_bf16 v[48:63], v[84:87], v[156:159], v[48:63]
  ds_read_b128 v[76:79], v2 offset:58368
  ds_read_b128 v[80:83], v2 offset:59392
  ds_read_b128 v[84:87], v2 offset:60416
  s_waitcnt vmcnt(13)
  s_waitcnt lgkmcnt(3)
  v_mfma_f32_32x32x16_bf16 v[16:31], v[64:67], v[160:163], v[16:31]
  s_add_u32 s100, s62, 32768
  buffer_load_dwordx4 v[136:139], v2, s[32:35], s100 offen offset:0 sc1
  v_mfma_f32_32x32x16_bf16 v[32:47], v[68:71], v[160:163], v[32:47]
  v_mfma_f32_32x32x16_bf16 v[48:63], v[72:75], v[160:163], v[48:63]
  ds_read_b128 v[64:67], v4 offset:0
  ds_read_b128 v[68:71], v4 offset:1024
  ds_read_b128 v[72:75], v4 offset:2048
  s_waitcnt vmcnt(13)
  s_waitcnt lgkmcnt(3)
  v_mfma_f32_32x32x16_bf16 v[16:31], v[76:79], v[164:167], v[16:31]
  s_add_u32 s100, s62, 32768
  buffer_load_dwordx4 v[140:143], v2, s[32:35], s100 offen offset:1024 sc1
  v_mfma_f32_32x32x16_bf16 v[32:47], v[80:83], v[164:167], v[32:47]
  v_mfma_f32_32x32x16_bf16 v[48:63], v[84:87], v[164:167], v[48:63]
  ds_read_b128 v[76:79], v4 offset:3072
  ds_read_b128 v[80:83], v4 offset:4096
  ds_read_b128 v[84:87], v4 offset:5120
  s_waitcnt vmcnt(13)
  s_waitcnt lgkmcnt(3)
  v_mfma_f32_32x32x16_bf16 v[16:31], v[64:67], v[88:91], v[16:31]
  s_add_u32 s100, s62, 32768
  buffer_load_dwordx4 v[144:147], v2, s[32:35], s100 offen offset:2048 sc1
  v_mfma_f32_32x32x16_bf16 v[32:47], v[68:71], v[88:91], v[32:47]
  v_mfma_f32_32x32x16_bf16 v[48:63], v[72:75], v[88:91], v[48:63]
  ds_read_b128 v[64:67], v4 offset:6144
  ds_read_b128 v[68:71], v4 offset:7168
  ds_read_b128 v[72:75], v4 offset:8192
  s_waitcnt vmcnt(13)
  s_waitcnt lgkmcnt(3)
  v_mfma_f32_32x32x16_bf16 v[16:31], v[76:79], v[92:95], v[16:31]
  s_add_u32 s100, s62, 32768
  buffer_load_dwordx4 v[148:151], v2, s[32:35], s100 offen offset:3072 sc1
  v_mfma_f32_32x32x16_bf16 v[32:47], v[80:83], v[92:95], v[32:47]
  v_mfma_f32_32x32x16_bf16 v[48:63], v[84:87], v[92:95], v[48:63]
  ds_read_b128 v[76:79], v4 offset:9216
  ds_read_b128 v[80:83], v4 offset:10240
  ds_read_b128 v[84:87], v4 offset:11264
  s_waitcnt vmcnt(13)
  s_waitcnt lgkmcnt(3)
  v_mfma_f32_32x32x16_bf16 v[16:31], v[64:67], v[96:99], v[16:31]
  s_add_u32 s100, s62, 36864
  buffer_load_dwordx4 v[152:155], v2, s[32:35], s100 offen offset:0 sc1
  v_mfma_f32_32x32x16_bf16 v[32:47], v[68:71], v[96:99], v[32:47]
  v_mfma_f32_32x32x16_bf16 v[48:63], v[72:75], v[96:99], v[48:63]
  s_lshl_b32 s101, s90, 10
  s_add_u32 s101, s101, 21561344
  v_and_b32 v8, 7, v1
  v_lshlrev_b32 v8, 7, v8
  buffer_load_dword v9, v8, s[32:35], s101 offen sc1
  ds_read_b128 v[64:67], v4 offset:12288
  ds_read_b128 v[68:71], v4 offset:13312
  ds_read_b128 v[72:75], v4 offset:14336
  s_waitcnt vmcnt(14)
  s_waitcnt lgkmcnt(3)
  v_mfma_f32_32x32x16_bf16 v[16:31], v[76:79], v[100:103], v[16:31]
  s_add_u32 s100, s62, 36864
  buffer_load_dwordx4 v[156:159], v2, s[32:35], s100 offen offset:1024 sc1
  v_mfma_f32_32x32x16_bf16 v[32:47], v[80:83], v[100:103], v[32:47]
  v_mfma_f32_32x32x16_bf16 v[48:63], v[84:87], v[100:103], v[48:63]
  ds_read_b128 v[76:79], v4 offset:15360
  ds_read_b128 v[80:83], v4 offset:16384
  ds_read_b128 v[84:87], v4 offset:17408
  s_waitcnt vmcnt(14)
  s_waitcnt lgkmcnt(3)
  v_mfma_f32_32x32x16_bf16 v[16:31], v[64:67], v[104:107], v[16:31]
  s_add_u32 s100, s62, 36864
  buffer_load_dwordx4 v[160:163], v2, s[32:35], s100 offen offset:2048 sc1
  v_mfma_f32_32x32x16_bf16 v[32:47], v[68:71], v[104:107], v[32:47]
  v_mfma_f32_32x32x16_bf16 v[48:63], v[72:75], v[104:107], v[48:63]
  ds_read_b128 v[64:67], v4 offset:18432
  ds_read_b128 v[68:71], v4 offset:19456
  ds_read_b128 v[72:75], v4 offset:20480
  s_waitcnt vmcnt(14)
  s_waitcnt lgkmcnt(3)
  v_mfma_f32_32x32x16_bf16 v[16:31], v[76:79], v[108:111], v[16:31]
  s_add_u32 s100, s62, 36864
  buffer_load_dwordx4 v[164:167], v2, s[32:35], s100 offen offset:3072 sc1
  v_mfma_f32_32x32x16_bf16 v[32:47], v[80:83], v[108:111], v[32:47]
  v_mfma_f32_32x32x16_bf16 v[48:63], v[84:87], v[108:111], v[48:63]
  ds_read_b128 v[76:79], v4 offset:21504
  ds_read_b128 v[80:83], v4 offset:22528
  ds_read_b128 v[84:87], v4 offset:23552
  s_waitcnt vmcnt(14)
  s_waitcnt lgkmcnt(3)
  v_mfma_f32_32x32x16_bf16 v[16:31], v[64:67], v[112:115], v[16:31]
  v_mfma_f32_32x32x16_bf16 v[32:47], v[68:71], v[112:115], v[32:47]
  v_mfma_f32_32x32x16_bf16 v[48:63], v[72:75], v[112:115], v[48:63]
  ds_read_b128 v[64:67], v4 offset:24576
  ds_read_b128 v[68:71], v4 offset:25600
  ds_read_b128 v[72:75], v4 offset:26624
  s_waitcnt vmcnt(13)
  s_waitcnt lgkmcnt(3)
  v_mfma_f32_32x32x16_bf16 v[16:31], v[76:79], v[116:119], v[16:31]
  v_mfma_f32_32x32x16_bf16 v[32:47], v[80:83], v[116:119], v[32:47]
  v_mfma_f32_32x32x16_bf16 v[48:63], v[84:87], v[116:119], v[48:63]
  ds_read_b128 v[76:79], v4 offset:27648
  ds_read_b128 v[80:83], v4 offset:28672
  ds_read_b128 v[84:87], v4 offset:29696
  s_waitcnt vmcnt(12)
  s_waitcnt lgkmcnt(3)
  v_mfma_f32_32x32x16_bf16 v[16:31], v[64:67], v[120:123], v[16:31]
  v_mfma_f32_32x32x16_bf16 v[32:47], v[68:71], v[120:123], v[32:47]
  v_mfma_f32_32x32x16_bf16 v[48:63], v[72:75], v[120:123], v[48:63]
  ds_read_b128 v[64:67], v4 offset:30720
  ds_read_b128 v[68:71], v4 offset:31744
  ds_read_b128 v[72:75], v4 offset:32768
  s_waitcnt vmcnt(11)
  s_waitcnt lgkmcnt(3)
  v_mfma_f32_32x32x16_bf16 v[16:31], v[76:79], v[124:127], v[16:31]
  v_mfma_f32_32x32x16_bf16 v[32:47], v[80:83], v[124:127], v[32:47]
  v_mfma_f32_32x32x16_bf16 v[48:63], v[84:87], v[124:127], v[48:63]
  ds_read_b128 v[76:79], v4 offset:33792
  ds_read_b128 v[80:83], v4 offset:34816
  ds_read_b128 v[84:87], v4 offset:35840
  s_waitcnt vmcnt(10)
  s_waitcnt lgkmcnt(3)
  v_mfma_f32_32x32x16_bf16 v[16:31], v[64:67], v[128:131], v[16:31]
  v_mfma_f32_32x32x16_bf16 v[32:47], v[68:71], v[128:131], v[32:47]
  v_mfma_f32_32x32x16_bf16 v[48:63], v[72:75], v[128:131], v[48:63]
  s_waitcnt vmcnt(3)
  v_cmp_eq_u32 vcc, 0, v9
  ds_read_b128 v[64:67], v4 offset:36864
  ds_read_b128 v[68:71], v4 offset:37888
  ds_read_b128 v[72:75], v4 offset:38912
  s_waitcnt lgkmcnt(3)
  v_mfma_f32_32x32x16_bf16 v[16:31], v[76:79], v[132:135], v[16:31]
  v_mfma_f32_32x32x16_bf16 v[32:47], v[80:83], v[132:135], v[32:47]
  v_mfma_f32_32x32x16_bf16 v[48:63], v[84:87], v[132:135], v[48:63]
  s_cbranch_vccnz sps_127
sps_127_r:
  v_lshrrev_b32 v14, 1, v2
  buffer_load_dwordx2 v[8:9], v14, s[32:35], s65 offen offset:0 sc1
  buffer_load_dwordx2 v[10:11], v14, s[32:35], s65 offen offset:512 sc1
  buffer_load_dwordx2 v[12:13], v14, s[32:35], s65 offen offset:1024 sc1
  buffer_load_dwordx2 v[14:15], v14, s[32:35], s65 offen offset:1536 sc1
  ds_read_b128 v[76:79], v4 offset:39936
  ds_read_b128 v[80:83], v4 offset:40960
  ds_read_b128 v[84:87], v4 offset:41984
  s_waitcnt lgkmcnt(3)
  v_mfma_f32_32x32x16_bf16 v[16:31], v[64:67], v[136:139], v[16:31]
  v_mfma_f32_32x32x16_bf16 v[32:47], v[68:71], v[136:139], v[32:47]
  v_mfma_f32_32x32x16_bf16 v[48:63], v[72:75], v[136:139], v[48:63]
  ds_read_b128 v[64:67], v4 offset:43008
  ds_read_b128 v[68:71], v4 offset:44032
  ds_read_b128 v[72:75], v4 offset:45056
  s_waitcnt lgkmcnt(3)
  v_mfma_f32_32x32x16_bf16 v[16:31], v[76:79], v[140:143], v[16:31]
  s_add_u32 s100, s59, 20480
  buffer_load_dwordx4 v[136:139], v2, s[32:35], s100 offen offset:2048 sc1
  v_mfma_f32_32x32x16_bf16 v[32:47], v[80:83], v[140:143], v[32:47]
  v_mfma_f32_32x32x16_bf16 v[48:63], v[84:87], v[140:143], v[48:63]
  ds_read_b128 v[76:79], v4 offset:46080
  ds_read_b128 v[80:83], v4 offset:47104
  ds_read_b128 v[84:87], v4 offset:48128
  s_waitcnt lgkmcnt(3)
  v_mfma_f32_32x32x16_bf16 v[16:31], v[64:67], v[144:147], v[16:31]
  s_add_u32 s100, s59, 20480
  buffer_load_dwordx4 v[140:143], v2, s[32:35], s100 offen offset:3072 sc1
  v_mfma_f32_32x32x16_bf16 v[32:47], v[68:71], v[144:147], v[32:47]
  v_mfma_f32_32x32x16_bf16 v[48:63], v[72:75], v[144:147], v[48:63]
  ds_read_b128 v[64:67], v4 offset:49152
  ds_read_b128 v[68:71], v4 offset:50176
  ds_read_b128 v[72:75], v4 offset:51200
  s_waitcnt lgkmcnt(3)
  v_mfma_f32_32x32x16_bf16 v[16:31], v[76:79], v[148:151], v[16:31]
  s_add_u32 s100, s59, 24576
  buffer_load_dwordx4 v[144:147], v2, s[32:35], s100 offen offset:0 sc1
  v_mfma_f32_32x32x16_bf16 v[32:47], v[80:83], v[148:151], v[32:47]
  v_mfma_f32_32x32x16_bf16 v[48:63], v[84:87], v[148:151], v[48:63]
  ds_read_b128 v[76:79], v4 offset:52224
  ds_read_b128 v[80:83], v4 offset:53248
  ds_read_b128 v[84:87], v4 offset:54272
  s_waitcnt lgkmcnt(3)
  v_mfma_f32_32x32x16_bf16 v[16:31], v[64:67], v[152:155], v[16:31]
  s_add_u32 s100, s59, 24576
  buffer_load_dwordx4 v[148:151], v2, s[32:35], s100 offen offset:1024 sc1
  v_mfma_f32_32x32x16_bf16 v[32:47], v[68:71], v[152:155], v[32:47]
  v_mfma_f32_32x32x16_bf16 v[48:63], v[72:75], v[152:155], v[48:63]
  ds_read_b128 v[64:67], v4 offset:55296
  ds_read_b128 v[68:71], v4 offset:56320
  ds_read_b128 v[72:75], v4 offset:57344
  s_waitcnt vmcnt(10)
  s_waitcnt lgkmcnt(3)
  v_mfma_f32_32x32x16_bf16 v[16:31], v[76:79], v[156:159], v[16:31]
  s_add_u32 s100, s59, 24576
  buffer_load_dwordx4 v[152:155], v2, s[32:35], s100 offen offset:2048 sc1
  v_mfma_f32_32x32x16_bf16 v[32:47], v[80:83], v[156:159], v[32:47]
  v_mfma_f32_32x32x16_bf16 v[48:63], v[84:87], v[156:159], v[48:63]
  ds_read_b128 v[76:79], v4 offset:58368
  ds_read_b128 v[80:83], v4 offset:59392
  ds_read_b128 v[84:87], v4 offset:60416
  s_waitcnt vmcnt(10)
  s_waitcnt lgkmcnt(3)
  v_mfma_f32_32x32x16_bf16 v[16:31], v[64:67], v[160:163], v[16:31]
  s_add_u32 s100, s59, 24576
  buffer_load_dwordx4 v[156:159], v2, s[32:35], s100 offen offset:3072 sc1
  v_mfma_f32_32x32x16_bf16 v[32:47], v[68:71], v[160:163], v[32:47]
  v_mfma_f32_32x32x16_bf16 v[48:63], v[72:75], v[160:163], v[48:63]
  s_waitcnt vmcnt(10)
  s_waitcnt lgkmcnt(0)
  v_mfma_f32_32x32x16_bf16 v[16:31], v[76:79], v[164:167], v[16:31]
  s_add_u32 s100, s59, 28672
  buffer_load_dwordx4 v[160:163], v2, s[32:35], s100 offen offset:0 sc1
  v_mfma_f32_32x32x16_bf16 v[32:47], v[80:83], v[164:167], v[32:47]
  v_mfma_f32_32x32x16_bf16 v[48:63], v[84:87], v[164:167], v[48:63]
  s_nop 11
  s_branch spk_128
sps_127:
  s_nop 15
  s_lshl_b32 s101, s90, 10
  s_add_u32 s101, s101, 21561344
  v_and_b32 v8, 7, v1
  v_lshlrev_b32 v8, 7, v8
  s_nop 2
prb_129:
  buffer_load_dword v9, v8, s[32:35], s101 offen sc1
  s_waitcnt vmcnt(0)
  v_cmp_eq_u32 vcc, 0, v9
  s_nop 4
  s_cbranch_vccz prbok_130
  s_sleep 8
  s_add_u32 s95, s95, 1
  s_cmp_gt_u32 s95, 20000
  s_cbranch_scc0 prb_129
prbok_130:
  s_branch sps_127_r
spk_128:
  s_waitcnt vmcnt(7)
  v_add_f32 v8, v8, v10
  s_add_u32 s100, s59, 28672
  buffer_load_dwordx4 v[164:167], v2, s[32:35], s100 offen offset:1024 sc1
  v_add_f32 v9, v9, v11
  v_add_f32 v12, v12, v14
  v_add_f32 v13, v13, v15
  v_add_f32 v8, v8, v12
  v_add_f32 v9, v9, v13
  v_mov_b32 v10, v8
  v_mov_b32 v11, v9
  s_nop 0
  v_permlane32_swap_b32 v8, v10
  v_permlane32_swap_b32 v9, v11
  v_add_f32 v8, v8, v10
  v_add_f32 v9, v9, v11
  v_mul_f32 v8, 0xbacccccd, v8
  v_mul_f32 v9, 0x3acccccd, v9
  v_fma_f32 v9, -v8, v8, v9
  v_max_f32 v9, 0, v9
  v_add_f32 v9, 0x3727c5ac, v9
  v_rsq_f32 v9, v9
  s_nop 0
  v_mul_f32 v11, v9, v9
  v_mul_f32 v10, s78, v9
  v_mul_f32 v12, v11, v9
  v_mul_f32 v12, s79, v12
  v_rcp_f32 v11, v11
  ds_read_b128 v[64:67], v6 offset:0
  ds_read_b128 v[68:71], v6 offset:32
  ds_read_b128 v[72:75], v6 offset:64
  ds_read_b128 v[76:79], v6 offset:96
  s_waitcnt lgkmcnt(0)
  v_fma_f32 v16, v8, v64, v16
  v_fma_f32 v17, v8, v65, v17
  v_fma_f32 v18, v8, v66, v18
  v_fma_f32 v19, v8, v67, v19
  v_fma_f32 v20, v8, v68, v20
  v_fma_f32 v21, v8, v69, v21
  v_fma_f32 v22, v8, v70, v22
  v_fma_f32 v23, v8, v71, v23
  v_fma_f32 v24, v8, v72, v24
  v_fma_f32 v25, v8, v73, v25
  v_fma_f32 v26, v8, v74, v26
  v_fma_f32 v27, v8, v75, v27
  v_fma_f32 v28, v8, v76, v28
  v_fma_f32 v29, v8, v77, v29
  v_fma_f32 v30, v8, v78, v30
  v_fma_f32 v31, v8, v79, v31
  ds_read_b128 v[64:67], v6 offset:128
  ds_read_b128 v[68:71], v6 offset:160
  ds_read_b128 v[72:75], v6 offset:192
  ds_read_b128 v[76:79], v6 offset:224
  v_mul_f32 v80, v16, v16
  v_mul_f32 v81, v17, v17
  v_mul_f32 v82, v18, v18
  v_mul_f32 v83, v19, v19
  v_mul_f32 v84, v20, v20
  v_mul_f32 v85, v21, v21
  v_mul_f32 v86, v22, v22
  v_mul_f32 v87, v23, v23
  v_fma_f32 v80, v80, v12, v10
  v_fma_f32 v81, v81, v12, v10
  v_fma_f32 v82, v82, v12, v10
  v_fma_f32 v83, v83, v12, v10
  v_fma_f32 v84, v84, v12, v10
  v_fma_f32 v85, v85, v12, v10
  v_fma_f32 v86, v86, v12, v10
  v_fma_f32 v87, v87, v12, v10
  v_mul_f32 v80, v80, v16
  v_mul_f32 v81, v81, v17
  v_mul_f32 v82, v82, v18
  v_mul_f32 v83, v83, v19
  v_mul_f32 v84, v84, v20
  v_mul_f32 v85, v85, v21
  v_mul_f32 v86, v86, v22
  v_mul_f32 v87, v87, v23
  v_exp_f32 v80, v80
  v_exp_f32 v81, v81
  v_exp_f32 v82, v82
  v_exp_f32 v83, v83
  v_exp_f32 v84, v84
  v_exp_f32 v85, v85
  v_exp_f32 v86, v86
  v_exp_f32 v87, v87
  v_mul_f32 v16, v16, v24
  v_mul_f32 v17, v17, v25
  v_mul_f32 v18, v18, v26
  v_mul_f32 v19, v19, v27
  v_mul_f32 v20, v20, v28
  v_mul_f32 v21, v21, v29
  v_mul_f32 v22, v22, v30
  v_mul_f32 v23, v23, v31
  v_fma_f32 v80, v80, v11, v11
  v_fma_f32 v81, v81, v11, v11
  v_fma_f32 v82, v82, v11, v11
  v_fma_f32 v83, v83, v11, v11
  v_fma_f32 v84, v84, v11, v11
  v_fma_f32 v85, v85, v11, v11
  v_fma_f32 v86, v86, v11, v11
  v_fma_f32 v87, v87, v11, v11
  v_rcp_f32 v80, v80
  v_rcp_f32 v81, v81
  v_rcp_f32 v82, v82
  v_rcp_f32 v83, v83
  v_rcp_f32 v84, v84
  v_rcp_f32 v85, v85
  v_rcp_f32 v86, v86
  v_rcp_f32 v87, v87
  v_mul_f32 v16, v16, v80
  v_mul_f32 v17, v17, v81
  v_mul_f32 v18, v18, v82
  v_mul_f32 v19, v19, v83
  v_mul_f32 v20, v20, v84
  v_mul_f32 v21, v21, v85
  v_mul_f32 v22, v22, v86
  v_mul_f32 v23, v23, v87
  v_cvt_pk_bf16_f32 v24, v16, v17
  v_cvt_pk_bf16_f32 v25, v18, v19
  v_cvt_pk_bf16_f32 v26, v20, v21
  v_cvt_pk_bf16_f32 v27, v22, v23
  buffer_store_dwordx4 v[24:27], v2, s[32:35], s66 offen offset:0 sc1
  s_waitcnt lgkmcnt(0)
  v_fma_f32 v32, v8, v64, v32
  v_fma_f32 v33, v8, v65, v33
  v_fma_f32 v34, v8, v66, v34
  v_fma_f32 v35, v8, v67, v35
  v_fma_f32 v36, v8, v68, v36
  v_fma_f32 v37, v8, v69, v37
  v_fma_f32 v38, v8, v70, v38
  v_fma_f32 v39, v8, v71, v39
  v_fma_f32 v40, v8, v72, v40
  v_fma_f32 v41, v8, v73, v41
  v_fma_f32 v42, v8, v74, v42
  v_fma_f32 v43, v8, v75, v43
  v_fma_f32 v44, v8, v76, v44
  v_fma_f32 v45, v8, v77, v45
  v_fma_f32 v46, v8, v78, v46
  v_fma_f32 v47, v8, v79, v47
  ds_read_b128 v[64:67], v6 offset:256
  ds_read_b128 v[68:71], v6 offset:288
  ds_read_b128 v[72:75], v6 offset:320
  ds_read_b128 v[76:79], v6 offset:352
  v_mul_f32 v80, v32, v32
  v_mul_f32 v81, v33, v33
  v_mul_f32 v82, v34, v34
  v_mul_f32 v83, v35, v35
  v_mul_f32 v84, v36, v36
  v_mul_f32 v85, v37, v37
  v_mul_f32 v86, v38, v38
  v_mul_f32 v87, v39, v39
  v_fma_f32 v80, v80, v12, v10
  v_fma_f32 v81, v81, v12, v10
  v_fma_f32 v82, v82, v12, v10
  v_fma_f32 v83, v83, v12, v10
  v_fma_f32 v84, v84, v12, v10
  v_fma_f32 v85, v85, v12, v10
  v_fma_f32 v86, v86, v12, v10
  v_fma_f32 v87, v87, v12, v10
  v_mul_f32 v80, v80, v32
  v_mul_f32 v81, v81, v33
  v_mul_f32 v82, v82, v34
  v_mul_f32 v83, v83, v35
  v_mul_f32 v84, v84, v36
  v_mul_f32 v85, v85, v37
  v_mul_f32 v86, v86, v38
  v_mul_f32 v87, v87, v39
  v_exp_f32 v80, v80
  v_exp_f32 v81, v81
  v_exp_f32 v82, v82
  v_exp_f32 v83, v83
  v_exp_f32 v84, v84
  v_exp_f32 v85, v85
  v_exp_f32 v86, v86
  v_exp_f32 v87, v87
  v_mul_f32 v32, v32, v40
  v_mul_f32 v33, v33, v41
  v_mul_f32 v34, v34, v42
  v_mul_f32 v35, v35, v43
  v_mul_f32 v36, v36, v44
  v_mul_f32 v37, v37, v45
  v_mul_f32 v38, v38, v46
  v_mul_f32 v39, v39, v47
  v_fma_f32 v80, v80, v11, v11
  v_fma_f32 v81, v81, v11, v11
  v_fma_f32 v82, v82, v11, v11
  v_fma_f32 v83, v83, v11, v11
  v_fma_f32 v84, v84, v11, v11
  v_fma_f32 v85, v85, v11, v11
  v_fma_f32 v86, v86, v11, v11
  v_fma_f32 v87, v87, v11, v11
  v_rcp_f32 v80, v80
  v_rcp_f32 v81, v81
  v_rcp_f32 v82, v82
  v_rcp_f32 v83, v83
  v_rcp_f32 v84, v84
  v_rcp_f32 v85, v85
  v_rcp_f32 v86, v86
  v_rcp_f32 v87, v87
  v_mul_f32 v32, v32, v80
  v_mul_f32 v33, v33, v81
  v_mul_f32 v34, v34, v82
  v_mul_f32 v35, v35, v83
  v_mul_f32 v36, v36, v84
  v_mul_f32 v37, v37, v85
  v_mul_f32 v38, v38, v86
  v_mul_f32 v39, v39, v87
  v_cvt_pk_bf16_f32 v40, v32, v33
  v_cvt_pk_bf16_f32 v41, v34, v35
  v_cvt_pk_bf16_f32 v42, v36, v37
  v_cvt_pk_bf16_f32 v43, v38, v39
  buffer_store_dwordx4 v[40:43], v2, s[32:35], s66 offen offset:1024 sc1
  s_waitcnt lgkmcnt(0)
  v_fma_f32 v48, v8, v64, v48
  v_fma_f32 v49, v8, v65, v49
  v_fma_f32 v50, v8, v66, v50
  v_fma_f32 v51, v8, v67, v51
  v_fma_f32 v52, v8, v68, v52
  v_fma_f32 v53, v8, v69, v53
  v_fma_f32 v54, v8, v70, v54
  v_fma_f32 v55, v8, v71, v55
  v_fma_f32 v56, v8, v72, v56
  v_fma_f32 v57, v8, v73, v57
  v_fma_f32 v58, v8, v74, v58
  v_fma_f32 v59, v8, v75, v59
  v_fma_f32 v60, v8, v76, v60
  v_fma_f32 v61, v8, v77, v61
  v_fma_f32 v62, v8, v78, v62
  v_fma_f32 v63, v8, v79, v63
  v_mul_f32 v80, v48, v48
  v_mul_f32 v81, v49, v49
  v_mul_f32 v82, v50, v50
  v_mul_f32 v83, v51, v51
  v_mul_f32 v84, v52, v52
  v_mul_f32 v85, v53, v53
  v_mul_f32 v86, v54, v54
  v_mul_f32 v87, v55, v55
  v_fma_f32 v80, v80, v12, v10
  v_fma_f32 v81, v81, v12, v10
  v_fma_f32 v82, v82, v12, v10
  v_fma_f32 v83, v83, v12, v10
  v_fma_f32 v84, v84, v12, v10
  v_fma_f32 v85, v85, v12, v10
  v_fma_f32 v86, v86, v12, v10
  v_fma_f32 v87, v87, v12, v10
  v_mul_f32 v80, v80, v48
  v_mul_f32 v81, v81, v49
  v_mul_f32 v82, v82, v50
  v_mul_f32 v83, v83, v51
  v_mul_f32 v84, v84, v52
  v_mul_f32 v85, v85, v53
  v_mul_f32 v86, v86, v54
  v_mul_f32 v87, v87, v55
  v_exp_f32 v80, v80
  v_exp_f32 v81, v81
  v_exp_f32 v82, v82
  v_exp_f32 v83, v83
  v_exp_f32 v84, v84
  v_exp_f32 v85, v85
  v_exp_f32 v86, v86
  v_exp_f32 v87, v87
  v_mul_f32 v48, v48, v56
  v_mul_f32 v49, v49, v57
  v_mul_f32 v50, v50, v58
  v_mul_f32 v51, v51, v59
  v_mul_f32 v52, v52, v60
  v_mul_f32 v53, v53, v61
  v_mul_f32 v54, v54, v62
  v_mul_f32 v55, v55, v63
  v_fma_f32 v80, v80, v11, v11
  v_fma_f32 v81, v81, v11, v11
  v_fma_f32 v82, v82, v11, v11
  v_fma_f32 v83, v83, v11, v11
  v_fma_f32 v84, v84, v11, v11
  v_fma_f32 v85, v85, v11, v11
  v_fma_f32 v86, v86, v11, v11
  v_fma_f32 v87, v87, v11, v11
  v_rcp_f32 v80, v80
  v_rcp_f32 v81, v81
  v_rcp_f32 v82, v82
  v_rcp_f32 v83, v83
  v_rcp_f32 v84, v84
  v_rcp_f32 v85, v85
  v_rcp_f32 v86, v86
  v_rcp_f32 v87, v87
  v_mul_f32 v48, v48, v80
  v_mul_f32 v49, v49, v81
  v_mul_f32 v50, v50, v82
  v_mul_f32 v51, v51, v83
  v_mul_f32 v52, v52, v84
  v_mul_f32 v53, v53, v85
  v_mul_f32 v54, v54, v86
  v_mul_f32 v55, v55, v87
  v_cvt_pk_bf16_f32 v56, v48, v49
  v_cvt_pk_bf16_f32 v57, v50, v51
  v_cvt_pk_bf16_f32 v58, v52, v53
  v_cvt_pk_bf16_f32 v59, v54, v55
  buffer_store_dwordx4 v[56:59], v2, s[32:35], s66 offen offset:2048 sc1
  s_lshl_b32 s52, s90, 12
  s_lshl_b32 s53, s88, 7
  s_add_u32 s52, s52, s53
  s_add_u32 s52, s52, 21233664
  s_waitcnt vmcnt(0)
  v_mov_b32 v8, 1
  s_mov_b64 exec, 1
  buffer_store_dword v8, off, s[32:35], s52 sc1
  s_mov_b64 exec, -1
  s_lshl_b32 s101, s86, 12
  s_lshl_b32 s52, s3, 9
  s_add_u32 s101, s101, s52
  s_add_u32 s101, s101, 21233664
  v_and_b32 v8, 3, v1
  v_lshlrev_b32 v8, 7, v8
  s_nop 2
prb_131:
  buffer_load_dword v9, v8, s[32:35], s101 offen sc1
  s_waitcnt vmcnt(0)
  v_cmp_eq_u32 vcc, 0, v9
  s_nop 4
  s_cbranch_vccz prbok_132
  s_sleep 2
  s_add_u32 s95, s95, 1
  s_cmp_gt_u32 s95, 20000
  s_cbranch_scc0 prb_131
prbok_132:
  s_add_u32 s100, s63, 0
  buffer_load_dwordx4 v[88:91], v7, s[32:35], s100 offen offset:0 sc1
  s_add_u32 s100, s63, 0
  buffer_load_dwordx4 v[92:95], v7, s[32:35], s100 offen offset:256 sc1
  s_add_u32 s100, s63, 0
  buffer_load_dwordx4 v[96:99], v7, s[32:35], s100 offen offset:2048 sc1
  s_add_u32 s100, s63, 0
  buffer_load_dwordx4 v[100:103], v7, s[32:35], s100 offen offset:2304 sc1
  s_add_u32 s100, s63, 4096
  buffer_load_dwordx4 v[104:107], v7, s[32:35], s100 offen offset:0 sc1
  s_add_u32 s100, s63, 4096
  buffer_load_dwordx4 v[108:111], v7, s[32:35], s100 offen offset:256 sc1
  s_add_u32 s100, s63, 4096
  buffer_load_dwordx4 v[112:115], v7, s[32:35], s100 offen offset:2048 sc1
  s_add_u32 s100, s63, 4096
  buffer_load_dwordx4 v[116:119], v7, s[32:35], s100 offen offset:2304 sc1
  s_add_u32 s100, s63, 8192
  buffer_load_dwordx4 v[120:123], v7, s[32:35], s100 offen offset:0 sc1
  s_add_u32 s100, s63, 8192
  buffer_load_dwordx4 v[124:127], v7, s[32:35], s100 offen offset:256 sc1
  s_add_u32 s100, s63, 8192
  buffer_load_dwordx4 v[128:131], v7, s[32:35], s100 offen offset:2048 sc1
  s_add_u32 s100, s63, 8192
  buffer_load_dwordx4 v[132:135], v7, s[32:35], s100 offen offset:2304 sc1
  s_branch s3j_95
s3g1_94:
  v_mov_b32 v6, 2828
  s_nop 2
gw_133:
  ds_read_b32 v7, v6
  s_waitcnt lgkmcnt(0)
  v_readfirstlane_b32 s52, v7
  s_nop 1
  s_cmp_ge_u32 s52, 4
  s_nop 1
  s_cbranch_scc1 gwok_134
  s_sleep 1
  s_add_u32 s95, s95, 1
  s_cmp_gt_u32 s95, 1000000
  s_cbranch_scc0 gw_133
gwok_134:
  s_add_u32 m0, s58, 92160
  s_add_u32 s100, s57, 92160
  buffer_load_dwordx4 v2, s[32:35], s100 offen sc1 lds
  s_add_u32 m0, s58, 96256
  s_add_u32 s100, s57, 96256
  buffer_load_dwordx4 v2, s[32:35], s100 offen sc1 lds
  s_add_u32 m0, s58, 100352
  s_add_u32 s100, s57, 100352
  buffer_load_dwordx4 v2, s[32:35], s100 offen sc1 lds
  s_add_u32 m0, s58, 104448
  s_add_u32 s100, s57, 104448
  buffer_load_dwordx4 v2, s[32:35], s100 offen sc1 lds
  s_add_u32 m0, s58, 108544
  s_add_u32 s100, s57, 108544
  buffer_load_dwordx4 v2, s[32:35], s100 offen sc1 lds
  s_add_u32 m0, s58, 112640
  s_add_u32 s100, s57, 112640
  buffer_load_dwordx4 v2, s[32:35], s100 offen sc1 lds
  s_add_u32 m0, s58, 116736
  s_add_u32 s100, s57, 116736
  buffer_load_dwordx4 v2, s[32:35], s100 offen sc1 lds
  v_lshrrev_b32 v8, 1, v2
  v_add_f32 v16, v200, v202
  v_add_f32 v17, v201, v203
  v_add_f32 v16, v16, v204
  v_add_f32 v17, v17, v205
  v_add_f32 v16, v16, v206
  v_add_f32 v17, v17, v207
  v_add_f32 v16, v16, v208
  v_add_f32 v17, v17, v209
  v_add_f32 v16, v16, v210
  v_add_f32 v17, v17, v211
  v_add_f32 v16, v16, v212
  v_add_f32 v17, v17, v213
  v_add_f32 v16, v16, v214
  v_add_f32 v17, v17, v215
  v_add_f32 v16, v16, v216
  v_add_f32 v17, v17, v217
  v_add_f32 v16, v16, v218
  v_add_f32 v17, v17, v219
  s_lshr_b32 s52, s58, 1
  s_add_u32 s52, s52, 120832
  v_add_u32 v9, s52, v8
  ds_write_b64 v9, v[16:17]
  s_waitcnt lgkmcnt(0)
  v_mov_b32 v6, 2820
  v_mov_b32 v7, 1
  s_mov_b64 exec, 1
  ds_add_u32 v6, v7
  s_mov_b64 exec, -1
  v_mov_b32 v6, 2820
  s_nop 2
gw_135:
  ds_read_b32 v7, v6
  s_waitcnt lgkmcnt(0)
  v_readfirstlane_b32 s52, v7
  s_nop 1
  s_cmp_ge_u32 s52, 4
  s_nop 1
  s_cbranch_scc1 gwok_136
  s_sleep 1
  s_add_u32 s95, s95, 1
  s_cmp_gt_u32 s95, 1000000
  s_cbranch_scc0 gw_135
gwok_136:
  v_add_u32 v9, 120832, v8
  ds_read_b64 v[16:17], v9 offset:0
  ds_read_b64 v[18:19], v9 offset:512
  ds_read_b64 v[20:21], v9 offset:1024
  ds_read_b64 v[22:23], v9 offset:1536
  s_waitcnt lgkmcnt(0)
  v_add_f32 v16, v16, v18
  v_add_f32 v17, v17, v19
  v_add_f32 v16, v16, v20
  v_add_f32 v17, v17, v21
  v_add_f32 v16, v16, v22
  v_add_f32 v17, v17, v23
  ds_write_b64 v8, v[16:17] offset:2048
  s_waitcnt lgkmcnt(0)
  v_mov_b32 v6, 2820
  v_mov_b32 v7, 1
  s_mov_b64 exec, 1
  ds_add_u32 v6, v7
  s_mov_b64 exec, -1
  v_mov_b32 v6, 2820
  s_nop 2
gw_137:
  ds_read_b32 v7, v6
  s_waitcnt lgkmcnt(0)
  v_readfirstlane_b32 s52, v7
  s_nop 1
  s_cmp_ge_u32 s52, 8
  s_nop 1
  s_cbranch_scc1 gwok_138
  s_sleep 1
  s_add_u32 s95, s95, 1
  s_cmp_gt_u32 s95, 1000000
  s_cbranch_scc0 gw_137
gwok_138:
  s_cmp_ge_u32 s3, 6
  s_cbranch_scc1 w4q_139
  s_add_u32 m0, s58, 120832
  s_add_u32 s100, s57, 120832
  buffer_load_dwordx4 v2, s[32:35], s100 offen sc1 lds
w4q_139:
  buffer_load_dwordx4 v[168:171], v2, s[32:35], s59 offen offset:0 sc1
  buffer_load_dwordx4 v[172:175], v2, s[32:35], s59 offen offset:1024 sc1
  buffer_load_dwordx4 v[176:179], v2, s[32:35], s59 offen offset:2048 sc1
  buffer_load_dwordx4 v[180:183], v2, s[32:35], s59 offen offset:3072 sc1
  s_add_u32 s100, s59, 4096
  buffer_load_dwordx4 v[184:187], v2, s[32:35], s100 offen offset:0 sc1
  s_add_u32 s100, s59, 4096
  buffer_load_dwordx4 v[188:191], v2, s[32:35], s100 offen offset:1024 sc1
  s_add_u32 s100, s59, 4096
  buffer_load_dwordx4 v[192:195], v2, s[32:35], s100 offen offset:2048 sc1
  s_add_u32 s100, s59, 4096
  buffer_load_dwordx4 v[196:199], v2, s[32:35], s100 offen offset:3072 sc1
  s_add_u32 s100, s59, 8192
  buffer_load_dwordx4 v[200:203], v2, s[32:35], s100 offen offset:0 sc1
  s_add_u32 s100, s59, 8192
  buffer_load_dwordx4 v[204:207], v2, s[32:35], s100 offen offset:1024 sc1
  s_add_u32 s100, s59, 8192
  buffer_load_dwordx4 v[208:211], v2, s[32:35], s100 offen offset:2048 sc1
  s_add_u32 s100, s59, 8192
  buffer_load_dwordx4 v[212:215], v2, s[32:35], s100 offen offset:3072 sc1
  s_add_u32 s100, s59, 12288
  buffer_load_dwordx4 v[216:219], v2, s[32:35], s100 offen offset:0 sc1
  s_add_u32 s100, s59, 12288
  buffer_load_dwordx4 v[220:223], v2, s[32:35], s100 offen offset:1024 sc1
  s_add_u32 s100, s59, 12288
  buffer_load_dwordx4 v[224:227], v2, s[32:35], s100 offen offset:2048 sc1
  s_add_u32 s100, s59, 12288
  buffer_load_dwordx4 v[228:231], v2, s[32:35], s100 offen offset:3072 sc1
  s_add_u32 s100, s59, 16384
  buffer_load_dwordx4 v[232:235], v2, s[32:35], s100 offen offset:0 sc1
  s_add_u32 s100, s59, 16384
  buffer_load_dwordx4 v[236:239], v2, s[32:35], s100 offen offset:1024 sc1
  s_add_u32 s100, s59, 16384
  buffer_load_dwordx4 v[240:243], v2, s[32:35], s100 offen offset:2048 sc1
  s_add_u32 s100, s59, 16384
  buffer_load_dwordx4 v[244:247], v2, s[32:35], s100 offen offset:3072 sc1
  s_add_u32 s100, s59, 20480
  buffer_load_dwordx4 v[248:251], v2, s[32:35], s100 offen offset:0 sc1
  s_add_u32 s100, s59, 20480
  buffer_load_dwordx4 v[252:255], v2, s[32:35], s100 offen offset:1024 sc1
  s_waitcnt vmcnt(22)
  s_waitcnt lgkmcnt(0)
  v_mov_b32 v6, 2820
  v_mov_b32 v7, 1
  s_mov_b64 exec, 1
  ds_add_u32 v6, v7
  s_mov_b64 exec, -1
  v_mov_b32 v6, 2820
  s_nop 2
gw_140:
  ds_read_b32 v7, v6
  s_waitcnt lgkmcnt(0)
  v_readfirstlane_b32 s52, v7
  s_nop 1
  s_cmp_ge_u32 s52, 12
  s_nop 1
  s_cbranch_scc1 gwok_141
  s_sleep 1
  s_add_u32 s95, s95, 1
  s_cmp_gt_u32 s95, 1000000
  s_cbranch_scc0 gw_140
gwok_141:
  s_setprio 1
  v_add_u32 v4, 61440, v2
  v_lshrrev_b32 v8, 5, v1
  v_lshlrev_b32 v8, 4, v8
  v_add_u32 v6, 2048, v8
  v_lshrrev_b32 v8, 4, v1
  v_and_b32 v9, 15, v1
  v_lshlrev_b32 v8, 9, v8
  v_lshl_add_u32 v7, v9, 4, v8
  s_mov_b32 s78, 0xc0135761
  s_mov_b32 s79, 0xbdd2d3e8
  s_sub_u32 s52, s57, s58
  buffer_load_dwordx4 v[64:67], v2, s[32:35], s52 offen offset:0 sc1
  buffer_load_dwordx4 v[68:71], v2, s[32:35], s52 offen offset:1024 sc1
  buffer_load_dwordx4 v[72:75], v2, s[32:35], s52 offen offset:2048 sc1
  s_lshl_b32 s101, s90, 10
  s_add_u32 s101, s101, 21495808
  v_and_b32 v8, 7, v1
  v_lshlrev_b32 v8, 7, v8
  s_nop 2
prb_142:
  buffer_load_dword v9, v8, s[32:35], s101 offen sc1
  s_waitcnt vmcnt(0)
  v_cmp_eq_u32 vcc, 0, v9
  s_nop 4
  s_cbranch_vccz prbok_143
  s_sleep 8
  s_add_u32 s95, s95, 1
  s_cmp_gt_u32 s95, 20000
  s_cbranch_scc0 prb_142
prbok_143:
  buffer_load_dwordx4 v[88:91], v2, s[32:35], s62 offen offset:0 sc1
  buffer_load_dwordx4 v[92:95], v2, s[32:35], s62 offen offset:1024 sc1
  buffer_load_dwordx4 v[96:99], v2, s[32:35], s62 offen offset:2048 sc1
  buffer_load_dwordx4 v[100:103], v2, s[32:35], s62 offen offset:3072 sc1
  s_add_u32 s100, s62, 4096
  buffer_load_dwordx4 v[104:107], v2, s[32:35], s100 offen offset:0 sc1
  s_add_u32 s100, s62, 4096
  buffer_load_dwordx4 v[108:111], v2, s[32:35], s100 offen offset:1024 sc1
  s_add_u32 s100, s62, 4096
  buffer_load_dwordx4 v[112:115], v2, s[32:35], s100 offen offset:2048 sc1
  s_add_u32 s100, s62, 4096
  buffer_load_dwordx4 v[116:119], v2, s[32:35], s100 offen offset:3072 sc1
s4v_144:
  ds_read_b128 v[76:79], v2 offset:3072
  ds_read_b128 v[80:83], v2 offset:4096
  ds_read_b128 v[84:87], v2 offset:5120
  s_waitcnt vmcnt(7)
  v_mfma_f32_32x32x16_bf16 v[16:31], v[64:67], v[88:91], 0
  s_add_u32 s100, s62, 8192
  buffer_load_dwordx4 v[120:123], v2, s[32:35], s100 offen offset:0 sc1
  v_mfma_f32_32x32x16_bf16 v[32:47], v[68:71], v[88:91], 0
  s_add_u32 s100, s62, 8192
  buffer_load_dwordx4 v[124:127], v2, s[32:35], s100 offen offset:1024 sc1
  v_mfma_f32_32x32x16_bf16 v[48:63], v[72:75], v[88:91], 0
  ds_read_b128 v[64:67], v2 offset:6144
  ds_read_b128 v[68:71], v2 offset:7168
  ds_read_b128 v[72:75], v2 offset:8192
  s_waitcnt vmcnt(8)
  s_waitcnt lgkmcnt(3)
  v_mfma_f32_32x32x16_bf16 v[16:31], v[76:79], v[92:95], v[16:31]
  s_add_u32 s100, s62, 8192
  buffer_load_dwordx4 v[128:131], v2, s[32:35], s100 offen offset:2048 sc1
  v_mfma_f32_32x32x16_bf16 v[32:47], v[80:83], v[92:95], v[32:47]
  s_add_u32 s100, s62, 8192
  buffer_load_dwordx4 v[132:135], v2, s[32:35], s100 offen offset:3072 sc1
  v_mfma_f32_32x32x16_bf16 v[48:63], v[84:87], v[92:95], v[48:63]
  ds_read_b128 v[76:79], v2 offset:9216
  ds_read_b128 v[80:83], v2 offset:10240
  ds_read_b128 v[84:87], v2 offset:11264
  s_waitcnt vmcnt(9)
  s_waitcnt lgkmcnt(3)
  v_mfma_f32_32x32x16_bf16 v[16:31], v[64:67], v[96:99], v[16:31]
  s_add_u32 s100, s62, 12288
  buffer_load_dwordx4 v[136:139], v2, s[32:35], s100 offen offset:0 sc1
  v_mfma_f32_32x32x16_bf16 v[32:47], v[68:71], v[96:99], v[32:47]
  s_add_u32 s100, s62, 12288
  buffer_load_dwordx4 v[140:143], v2, s[32:35], s100 offen offset:1024 sc1
  v_mfma_f32_32x32x16_bf16 v[48:63], v[72:75], v[96:99], v[48:63]
  ds_read_b128 v[64:67], v2 offset:12288
  ds_read_b128 v[68:71], v2 offset:13312
  ds_read_b128 v[72:75], v2 offset:14336
  s_waitcnt vmcnt(10)
  s_waitcnt lgkmcnt(3)
  v_mfma_f32_32x32x16_bf16 v[16:31], v[76:79], v[100:103], v[16:31]
  s_add_u32 s100, s62, 12288
  buffer_load_dwordx4 v[144:147], v2, s[32:35], s100 offen offset:2048 sc1
  v_mfma_f32_32x32x16_bf16 v[32:47], v[80:83], v[100:103], v[32:47]
  s_add_u32 s100, s62, 12288
  buffer_load_dwordx4 v[148:151], v2, s[32:35], s100 offen offset:3072 sc1
  v_mfma_f32_32x32x16_bf16 v[48:63], v[84:87], v[100:103], v[48:63]
  ds_read_b128 v[76:79], v2 offset:15360
  ds_read_b128 v[80:83], v2 offset:16384
  ds_read_b128 v[84:87], v2 offset:17408
  s_waitcnt vmcnt(11)
  s_waitcnt lgkmcnt(3)
  v_mfma_f32_32x32x16_bf16 v[16:31], v[64:67], v[104:107], v[16:31]
  s_add_u32 s100, s62, 16384
  buffer_load_dwordx4 v[152:155], v2, s[32:35], s100 offen offset:0 sc1
  v_mfma_f32_32x32x16_bf16 v[32:47], v[68:71], v[104:107], v[32:47]
  s_add_u32 s100, s62, 16384
  buffer_load_dwordx4 v[156:159], v2, s[32:35], s100 offen offset:1024 sc1
  v_mfma_f32_32x32x16_bf16 v[48:63], v[72:75], v[104:107], v[48:63]
  ds_read_b128 v[64:67], v2 offset:18432
  ds_read_b128 v[68:71], v2 offset:19456
  ds_read_b128 v[72:75], v2 offset:20480
  s_waitcnt vmcnt(12)
  s_waitcnt lgkmcnt(3)
  v_mfma_f32_32x32x16_bf16 v[16:31], v[76:79], v[108:111], v[16:31]
  s_add_u32 s100, s62, 16384
  buffer_load_dwordx4 v[160:163], v2, s[32:35], s100 offen offset:2048 sc1
  v_mfma_f32_32x32x16_bf16 v[32:47], v[80:83], v[108:111], v[32:47]
  s_add_u32 s100, s62, 16384
  buffer_load_dwordx4 v[164:167], v2, s[32:35], s100 offen offset:3072 sc1
  v_mfma_f32_32x32x16_bf16 v[48:63], v[84:87], v[108:111], v[48:63]
  ds_read_b128 v[76:79], v2 offset:21504
  ds_read_b128 v[80:83], v2 offset:22528
  ds_read_b128 v[84:87], v2 offset:23552
  s_waitcnt vmcnt(13)
  s_waitcnt lgkmcnt(3)
  v_mfma_f32_32x32x16_bf16 v[16:31], v[64:67], v[112:115], v[16:31]
  s_add_u32 s100, s62, 20480
  buffer_load_dwordx4 v[88:91], v2, s[32:35], s100 offen offset:0 sc1
  v_mfma_f32_32x32x16_bf16 v[32:47], v[68:71], v[112:115], v[32:47]
  v_mfma_f32_32x32x16_bf16 v[48:63], v[72:75], v[112:115], v[48:63]
  ds_read_b128 v[64:67], v2 offset:24576
  ds_read_b128 v[68:71], v2 offset:25600
  ds_read_b128 v[72:75], v2 offset:26624
  s_waitcnt vmcnt(13)
  s_waitcnt lgkmcnt(3)
  v_mfma_f32_32x32x16_bf16 v[16:31], v[76:79], v[116:119], v[16:31]
  s_add_u32 s100, s62, 20480
  buffer_load_dwordx4 v[92:95], v2, s[32:35], s100 offen offset:1024 sc1
  v_mfma_f32_32x32x16_bf16 v[32:47], v[80:83], v[116:119], v[32:47]
  v_mfma_f32_32x32x16_bf16 v[48:63], v[84:87], v[116:119], v[48:63]
  ds_read_b128 v[76:79], v2 offset:27648
  ds_read_b128 v[80:83], v2 offset:28672
  ds_read_b128 v[84:87], v2 offset:29696
  s_waitcnt vmcnt(13)
  s_waitcnt lgkmcnt(3)
  v_mfma_f32_32x32x16_bf16 v[16:31], v[64:67], v[120:123], v[16:31]
  s_add_u32 s100, s62, 20480
  buffer_load_dwordx4 v[96:99], v2, s[32:35], s100 offen offset:2048 sc1
  v_mfma_f32_32x32x16_bf16 v[32:47], v[68:71], v[120:123], v[32:47]
  v_mfma_f32_32x32x16_bf16 v[48:63], v[72:75], v[120:123], v[48:63]
  ds_read_b128 v[64:67], v2 offset:30720
  ds_read_b128 v[68:71], v2 offset:31744
  ds_read_b128 v[72:75], v2 offset:32768
  s_waitcnt vmcnt(13)
  s_waitcnt lgkmcnt(3)
  v_mfma_f32_32x32x16_bf16 v[16:31], v[76:79], v[124:127], v[16:31]
  s_add_u32 s100, s62, 20480
  buffer_load_dwordx4 v[100:103], v2, s[32:35], s100 offen offset:3072 sc1
  v_mfma_f32_32x32x16_bf16 v[32:47], v[80:83], v[124:127], v[32:47]
  v_mfma_f32_32x32x16_bf16 v[48:63], v[84:87], v[124:127], v[48:63]
  ds_read_b128 v[76:79], v2 offset:33792
  ds_read_b128 v[80:83], v2 offset:34816
  ds_read_b128 v[84:87], v2 offset:35840
  s_waitcnt vmcnt(13)
  s_waitcnt lgkmcnt(3)
  v_mfma_f32_32x32x16_bf16 v[16:31], v[64:67], v[128:131], v[16:31]
  s_add_u32 s100, s62, 24576
  buffer_load_dwordx4 v[104:107], v2, s[32:35], s100 offen offset:0 sc1
  v_mfma_f32_32x32x16_bf16 v[32:47], v[68:71], v[128:131], v[32:47]
  v_mfma_f32_32x32x16_bf16 v[48:63], v[72:75], v[128:131], v[48:63]
  ds_read_b128 v[64:67], v2 offset:36864
  ds_read_b128 v[68:71], v2 offset:37888
  ds_read_b128 v[72:75], v2 offset:38912
  s_waitcnt vmcnt(13)
  s_waitcnt lgkmcnt(3)
  v_mfma_f32_32x32x16_bf16 v[16:31], v[76:79], v[132:135], v[16:31]
  s_add_u32 s100, s62, 24576
  buffer_load_dwordx4 v[108:111], v2, s[32:35], s100 offen offset:1024 sc1
  v_mfma_f32_32x32x16_bf16 v[32:47], v[80:83], v[132:135], v[32:47]
  v_mfma_f32_32x32x16_bf16 v[48:63], v[84:87], v[132:135], v[48:63]
  ds_read_b128 v[76:79], v2 offset:39936
  ds_read_b128 v[80:83], v2 offset:40960
  ds_read_b128 v[84:87], v2 offset:41984
  s_waitcnt vmcnt(13)
  s_waitcnt lgkmcnt(3)
  v_mfma_f32_32x32x16_bf16 v[16:31], v[64:67], v[136:139], v[16:31]
  s_add_u32 s100, s62, 24576
  buffer_load_dwordx4 v[112:115], v2, s[32:35], s100 offen offset:2048 sc1
  v_mfma_f32_32x32x16_bf16 v[32:47], v[68:71], v[136:139], v[32:47]
  v_mfma_f32_32x32x16_bf16 v[48:63], v[72:75], v[136:139], v[48:63]
  ds_read_b128 v[64:67], v2 offset:43008
  ds_read_b128 v[68:71], v2 offset:44032
  ds_read_b128 v[72:75], v2 offset:45056
  s_waitcnt vmcnt(13)
  s_waitcnt lgkmcnt(3)
  v_mfma_f32_32x32x16_bf16 v[16:31], v[76:79], v[140:143], v[16:31]
  s_add_u32 s100, s62, 24576
  buffer_load_dwordx4 v[116:119], v2, s[32:35], s100 offen offset:3072 sc1
  v_mfma_f32_32x32x16_bf16 v[32:47], v[80:83], v[140:143], v[32:47]
  v_mfma_f32_32x32x16_bf16 v[48:63], v[84:87], v[140:143], v[48:63]
  ds_read_b128 v[76:79], v2 offset:46080
  ds_read_b128 v[80:83], v2 offset:47104
  ds_read_b128 v[84:87], v2 offset:48128
  s_waitcnt vmcnt(13)
  s_waitcnt lgkmcnt(3)
  v_mfma_f32_32x32x16_bf16 v[16:31], v[64:67], v[144:147], v[16:31]
  s_add_u32 s100, s62, 28672
  buffer_load_dwordx4 v[120:123], v2, s[32:35], s100 offen offset:0 sc1
  v_mfma_f32_32x32x16_bf16 v[32:47], v[68:71], v[144:147], v[32:47]
  v_mfma_f32_32x32x16_bf16 v[48:63], v[72:75], v[144:147], v[48:63]
  ds_read_b128 v[64:67], v2 offset:49152
  ds_read_b128 v[68:71], v2 offset:50176
  ds_read_b128 v[72:75], v2 offset:51200
  s_waitcnt vmcnt(13)
  s_waitcnt lgkmcnt(3)
  v_mfma_f32_32x32x16_bf16 v[16:31], v[76:79], v[148:151], v[16:31]
  s_add_u32 s100, s62, 28672
  buffer_load_dwordx4 v[124:127], v2, s[32:35], s100 offen offset:1024 sc1
  v_mfma_f32_32x32x16_bf16 v[32:47], v[80:83], v[148:151], v[32:47]
  v_mfma_f32_32x32x16_bf16 v[48:63], v[84:87], v[148:151], v[48:63]
  ds_read_b128 v[76:79], v2 offset:52224
  ds_read_b128 v[80:83], v2 offset:53248
  ds_read_b128 v[84:87], v2 offset:54272
  s_waitcnt vmcnt(13)
  s_waitcnt lgkmcnt(3)
  v_mfma_f32_32x32x16_bf16 v[16:31], v[64:67], v[152:155], v[16:31]
  s_add_u32 s100, s62, 28672
  buffer_load_dwordx4 v[128:131], v2, s[32:35], s100 offen offset:2048 sc1
  v_mfma_f32_32x32x16_bf16 v[32:47], v[68:71], v[152:155], v[32:47]
  v_mfma_f32_32x32x16_bf16 v[48:63], v[72:75], v[152:155], v[48:63]
  ds_read_b128 v[64:67], v2 offset:55296
  ds_read_b128 v[68:71], v2 offset:56320
  ds_read_b128 v[72:75], v2 offset:57344
  s_waitcnt vmcnt(13)
  s_waitcnt lgkmcnt(3)
  v_mfma_f32_32x32x16_bf16 v[16:31], v[76:79], v[156:159], v[16:31]
  s_add_u32 s100, s62, 28672
  buffer_load_dwordx4 v[132:135], v2, s[32:35], s100 offen offset:3072 sc1
  v_mfma_f32_32x32x16_bf16 v[32:47], v[80:83], v[156:159], v[32:47]
  v_mfma_f32_32x32x16_bf16 v[48:63], v[84:87], v[156:159], v[48:63]
  ds_read_b128 v[76:79], v2 offset:58368
  ds_read_b128 v[80:83], v2 offset:59392
  ds_read_b128 v[84:87], v2 offset:60416
  s_waitcnt vmcnt(13)
  s_waitcnt lgkmcnt(3)
  v_mfma_f32_32x32x16_bf16 v[16:31], v[64:67], v[160:163], v[16:31]
  s_add_u32 s100, s62, 32768
  buffer_load_dwordx4 v[136:139], v2, s[32:35], s100 offen offset:0 sc1
  v_mfma_f32_32x32x16_bf16 v[32:47], v[68:71], v[160:163], v[32:47]
  v_mfma_f32_32x32x16_bf16 v[48:63], v[72:75], v[160:163], v[48:63]
  ds_read_b128 v[64:67], v4 offset:0
  ds_read_b128 v[68:71], v4 offset:1024
  ds_read_b128 v[72:75], v4 offset:2048
  s_waitcnt vmcnt(13)
  s_waitcnt lgkmcnt(3)
  v_mfma_f32_32x32x16_bf16 v[16:31], v[76:79], v[164:167], v[16:31]
  s_add_u32 s100, s62, 32768
  buffer_load_dwordx4 v[140:143], v2, s[32:35], s100 offen offset:1024 sc1
  v_mfma_f32_32x32x16_bf16 v[32:47], v[80:83], v[164:167], v[32:47]
  v_mfma_f32_32x32x16_bf16 v[48:63], v[84:87], v[164:167], v[48:63]
  ds_read_b128 v[76:79], v4 offset:3072
  ds_read_b128 v[80:83], v4 offset:4096
  ds_read_b128 v[84:87], v4 offset:5120
  s_waitcnt vmcnt(13)
  s_waitcnt lgkmcnt(3)
  v_mfma_f32_32x32x16_bf16 v[16:31], v[64:67], v[88:91], v[16:31]
  s_add_u32 s100, s62, 32768
  buffer_load_dwordx4 v[144:147], v2, s[32:35], s100 offen offset:2048 sc1
  v_mfma_f32_32x32x16_bf16 v[32:47], v[68:71], v[88:91], v[32:47]
  v_mfma_f32_32x32x16_bf16 v[48:63], v[72:75], v[88:91], v[48:63]
  ds_read_b128 v[64:67], v4 offset:6144
  ds_read_b128 v[68:71], v4 offset:7168
  ds_read_b128 v[72:75], v4 offset:8192
  s_waitcnt vmcnt(13)
  s_waitcnt lgkmcnt(3)
  v_mfma_f32_32x32x16_bf16 v[16:31], v[76:79], v[92:95], v[16:31]
  s_add_u32 s100, s62, 32768
  buffer_load_dwordx4 v[148:151], v2, s[32:35], s100 offen offset:3072 sc1
  v_mfma_f32_32x32x16_bf16 v[32:47], v[80:83], v[92:95], v[32:47]
  v_mfma_f32_32x32x16_bf16 v[48:63], v[84:87], v[92:95], v[48:63]
  ds_read_b128 v[76:79], v4 offset:9216
  ds_read_b128 v[80:83], v4 offset:10240
  ds_read_b128 v[84:87], v4 offset:11264
  s_waitcnt vmcnt(13)
  s_waitcnt lgkmcnt(3)
  v_mfma_f32_32x32x16_bf16 v[16:31], v[64:67], v[96:99], v[16:31]
  s_add_u32 s100, s62, 36864
  buffer_load_dwordx4 v[152:155], v2, s[32:35], s100 offen offset:0 sc1
  v_mfma_f32_32x32x16_bf16 v[32:47], v[68:71], v[96:99], v[32:47]
  v_mfma_f32_32x32x16_bf16 v[48:63], v[72:75], v[96:99], v[48:63]
  s_lshl_b32 s101, s90, 10
  s_add_u32 s101, s101, 21561344
  v_and_b32 v8, 7, v1
  v_lshlrev_b32 v8, 7, v8
  buffer_load_dword v9, v8, s[32:35], s101 offen sc1
  ds_read_b128 v[64:67], v4 offset:12288
  ds_read_b128 v[68:71], v4 offset:13312
  ds_read_b128 v[72:75], v4 offset:14336
  s_waitcnt vmcnt(14)
  s_waitcnt lgkmcnt(3)
  v_mfma_f32_32x32x16_bf16 v[16:31], v[76:79], v[100:103], v[16:31]
  s_add_u32 s100, s62, 36864
  buffer_load_dwordx4 v[156:159], v2, s[32:35], s100 offen offset:1024 sc1
  v_mfma_f32_32x32x16_bf16 v[32:47], v[80:83], v[100:103], v[32:47]
  v_mfma_f32_32x32x16_bf16 v[48:63], v[84:87], v[100:103], v[48:63]
  ds_read_b128 v[76:79], v4 offset:15360
  ds_read_b128 v[80:83], v4 offset:16384
  ds_read_b128 v[84:87], v4 offset:17408
  s_waitcnt vmcnt(14)
  s_waitcnt lgkmcnt(3)
  v_mfma_f32_32x32x16_bf16 v[16:31], v[64:67], v[104:107], v[16:31]
  s_add_u32 s100, s62, 36864
  buffer_load_dwordx4 v[160:163], v2, s[32:35], s100 offen offset:2048 sc1
  v_mfma_f32_32x32x16_bf16 v[32:47], v[68:71], v[104:107], v[32:47]
  v_mfma_f32_32x32x16_bf16 v[48:63], v[72:75], v[104:107], v[48:63]
  ds_read_b128 v[64:67], v4 offset:18432
  ds_read_b128 v[68:71], v4 offset:19456
  ds_read_b128 v[72:75], v4 offset:20480
  s_waitcnt vmcnt(14)
  s_waitcnt lgkmcnt(3)
  v_mfma_f32_32x32x16_bf16 v[16:31], v[76:79], v[108:111], v[16:31]
  s_add_u32 s100, s62, 36864
  buffer_load_dwordx4 v[164:167], v2, s[32:35], s100 offen offset:3072 sc1
  v_mfma_f32_32x32x16_bf16 v[32:47], v[80:83], v[108:111], v[32:47]
  v_mfma_f32_32x32x16_bf16 v[48:63], v[84:87], v[108:111], v[48:63]
  ds_read_b128 v[76:79], v4 offset:21504
  ds_read_b128 v[80:83], v4 offset:22528
  ds_read_b128 v[84:87], v4 offset:23552
  s_waitcnt vmcnt(14)
  s_waitcnt lgkmcnt(3)
  v_mfma_f32_32x32x16_bf16 v[16:31], v[64:67], v[112:115], v[16:31]
  v_mfma_f32_32x32x16_bf16 v[32:47], v[68:71], v[112:115], v[32:47]
  v_mfma_f32_32x32x16_bf16 v[48:63], v[72:75], v[112:115], v[48:63]
  ds_read_b128 v[64:67], v4 offset:24576
  ds_read_b128 v[68:71], v4 offset:25600
  ds_read_b128 v[72:75], v4 offset:26624
  s_waitcnt vmcnt(13)
  s_waitcnt lgkmcnt(3)
  v_mfma_f32_32x32x16_bf16 v[16:31], v[76:79], v[116:119], v[16:31]
  v_mfma_f32_32x32x16_bf16 v[32:47], v[80:83], v[116:119], v[32:47]
  v_mfma_f32_32x32x16_bf16 v[48:63], v[84:87], v[116:119], v[48:63]
  ds_read_b128 v[76:79], v4 offset:27648
  ds_read_b128 v[80:83], v4 offset:28672
  ds_read_b128 v[84:87], v4 offset:29696
  s_waitcnt vmcnt(12)
  s_waitcnt lgkmcnt(3)
  v_mfma_f32_32x32x16_bf16 v[16:31], v[64:67], v[120:123], v[16:31]
  v_mfma_f32_32x32x16_bf16 v[32:47], v[68:71], v[120:123], v[32:47]
  v_mfma_f32_32x32x16_bf16 v[48:63], v[72:75], v[120:123], v[48:63]
  ds_read_b128 v[64:67], v4 offset:30720
  ds_read_b128 v[68:71], v4 offset:31744
  ds_read_b128 v[72:75], v4 offset:32768
  s_waitcnt vmcnt(11)
  s_waitcnt lgkmcnt(3)
  v_mfma_f32_32x32x16_bf16 v[16:31], v[76:79], v[124:127], v[16:31]
  v_mfma_f32_32x32x16_bf16 v[32:47], v[80:83], v[124:127], v[32:47]
  v_mfma_f32_32x32x16_bf16 v[48:63], v[84:87], v[124:127], v[48:63]
  ds_read_b128 v[76:79], v4 offset:33792
  ds_read_b128 v[80:83], v4 offset:34816
  ds_read_b128 v[84:87], v4 offset:35840
  s_waitcnt vmcnt(10)
  s_waitcnt lgkmcnt(3)
  v_mfma_f32_32x32x16_bf16 v[16:31], v[64:67], v[128:131], v[16:31]
  v_mfma_f32_32x32x16_bf16 v[32:47], v[68:71], v[128:131], v[32:47]
  v_mfma_f32_32x32x16_bf16 v[48:63], v[72:75], v[128:131], v[48:63]
  s_waitcnt vmcnt(3)
  v_cmp_eq_u32 vcc, 0, v9
  ds_read_b128 v[64:67], v4 offset:36864
  ds_read_b128 v[68:71], v4 offset:37888
  ds_read_b128 v[72:75], v4 offset:38912
  s_waitcnt lgkmcnt(3)
  v_mfma_f32_32x32x16_bf16 v[16:31], v[76:79], v[132:135], v[16:31]
  v_mfma_f32_32x32x16_bf16 v[32:47], v[80:83], v[132:135], v[32:47]
  v_mfma_f32_32x32x16_bf16 v[48:63], v[84:87], v[132:135], v[48:63]
  s_cbranch_vccnz sps_146
sps_146_r:
  v_lshrrev_b32 v14, 1, v2
  buffer_load_dwordx2 v[8:9], v14, s[32:35], s65 offen offset:0 sc1
  buffer_load_dwordx2 v[10:11], v14, s[32:35], s65 offen offset:512 sc1
  buffer_load_dwordx2 v[12:13], v14, s[32:35], s65 offen offset:1024 sc1
  buffer_load_dwordx2 v[14:15], v14, s[32:35], s65 offen offset:1536 sc1
  ds_read_b128 v[76:79], v4 offset:39936
  ds_read_b128 v[80:83], v4 offset:40960
  ds_read_b128 v[84:87], v4 offset:41984
  s_waitcnt lgkmcnt(3)
  v_mfma_f32_32x32x16_bf16 v[16:31], v[64:67], v[136:139], v[16:31]
  v_mfma_f32_32x32x16_bf16 v[32:47], v[68:71], v[136:139], v[32:47]
  v_mfma_f32_32x32x16_bf16 v[48:63], v[72:75], v[136:139], v[48:63]
  ds_read_b128 v[64:67], v4 offset:43008
  ds_read_b128 v[68:71], v4 offset:44032
  ds_read_b128 v[72:75], v4 offset:45056
  s_waitcnt lgkmcnt(3)
  v_mfma_f32_32x32x16_bf16 v[16:31], v[76:79], v[140:143], v[16:31]
  v_mfma_f32_32x32x16_bf16 v[32:47], v[80:83], v[140:143], v[32:47]
  v_mfma_f32_32x32x16_bf16 v[48:63], v[84:87], v[140:143], v[48:63]
  ds_read_b128 v[76:79], v4 offset:46080
  ds_read_b128 v[80:83], v4 offset:47104
  ds_read_b128 v[84:87], v4 offset:48128
  s_waitcnt lgkmcnt(3)
  v_mfma_f32_32x32x16_bf16 v[16:31], v[64:67], v[144:147], v[16:31]
  v_mfma_f32_32x32x16_bf16 v[32:47], v[68:71], v[144:147], v[32:47]
  v_mfma_f32_32x32x16_bf16 v[48:63], v[72:75], v[144:147], v[48:63]
  ds_read_b128 v[64:67], v4 offset:49152
  ds_read_b128 v[68:71], v4 offset:50176
  ds_read_b128 v[72:75], v4 offset:51200
  s_waitcnt lgkmcnt(3)
  v_mfma_f32_32x32x16_bf16 v[16:31], v[76:79], v[148:151], v[16:31]
  v_mfma_f32_32x32x16_bf16 v[32:47], v[80:83], v[148:151], v[32:47]
  v_mfma_f32_32x32x16_bf16 v[48:63], v[84:87], v[148:151], v[48:63]
  ds_read_b128 v[76:79], v4 offset:52224
  ds_read_b128 v[80:83], v4 offset:53248
  ds_read_b128 v[84:87], v4 offset:54272
  s_waitcnt lgkmcnt(3)
  v_mfma_f32_32x32x16_bf16 v[16:31], v[64:67], v[152:155], v[16:31]
  v_mfma_f32_32x32x16_bf16 v[32:47], v[68:71], v[152:155], v[32:47]
  v_mfma_f32_32x32x16_bf16 v[48:63], v[72:75], v[152:155], v[48:63]
  ds_read_b128 v[64:67], v4 offset:55296
  ds_read_b128 v[68:71], v4 offset:56320
  ds_read_b128 v[72:75], v4 offset:57344
  s_waitcnt vmcnt(6)
  s_waitcnt lgkmcnt(3)
  v_mfma_f32_32x32x16_bf16 v[16:31], v[76:79], v[156:159], v[16:31]
  v_mfma_f32_32x32x16_bf16 v[32:47], v[80:83], v[156:159], v[32:47]
  v_mfma_f32_32x32x16_bf16 v[48:63], v[84:87], v[156:159], v[48:63]
  ds_read_b128 v[76:79], v4 offset:58368
  ds_read_b128 v[80:83], v4 offset:59392
  ds_read_b128 v[84:87], v4 offset:60416
  s_waitcnt vmcnt(5)
  s_waitcnt lgkmcnt(3)
  v_mfma_f32_32x32x16_bf16 v[16:31], v[64:67], v[160:163], v[16:31]
  v_mfma_f32_32x32x16_bf16 v[32:47], v[68:71], v[160:163], v[32:47]
  v_mfma_f32_32x32x16_bf16 v[48:63], v[72:75], v[160:163], v[48:63]
  s_waitcnt vmcnt(4)
  s_waitcnt lgkmcnt(0)
  v_mfma_f32_32x32x16_bf16 v[16:31], v[76:79], v[164:167], v[16:31]
  v_mfma_f32_32x32x16_bf16 v[32:47], v[80:83], v[164:167], v[32:47]
  v_mfma_f32_32x32x16_bf16 v[48:63], v[84:87], v[164:167], v[48:63]
  s_nop 11
  s_branch spk_147
sps_146:
  s_nop 15
  s_lshl_b32 s101, s90, 10
  s_add_u32 s101, s101, 21561344
  v_and_b32 v8, 7, v1
  v_lshlrev_b32 v8, 7, v8
  s_nop 2
prb_148:
  buffer_load_dword v9, v8, s[32:35], s101 offen sc1
  s_waitcnt vmcnt(0)
  v_cmp_eq_u32 vcc, 0, v9
  s_nop 4
  s_cbranch_vccz prbok_149
  s_sleep 8
  s_add_u32 s95, s95, 1
  s_cmp_gt_u32 s95, 20000
  s_cbranch_scc0 prb_148
prbok_149:
  s_branch sps_146_r
spk_147:
  s_setprio 1
  s_waitcnt vmcnt(0)
  v_add_f32 v8, v8, v10
  s_add_u32 s100, s59, 20480
  buffer_load_dwordx4 v[136:139], v2, s[32:35], s100 offen offset:2048 sc1
  v_add_f32 v9, v9, v11
  v_add_f32 v12, v12, v14
  v_add_f32 v13, v13, v15
  v_add_f32 v8, v8, v12
  v_add_f32 v9, v9, v13
  v_mov_b32 v10, v8
  v_mov_b32 v11, v9
  s_nop 0
  v_permlane32_swap_b32 v8, v10
  v_permlane32_swap_b32 v9, v11
  v_add_f32 v8, v8, v10
  v_add_f32 v9, v9, v11
  v_mul_f32 v8, 0xbacccccd, v8
  v_mul_f32 v9, 0x3acccccd, v9
  v_fma_f32 v9, -v8, v8, v9
  v_max_f32 v9, 0, v9
  s_add_u32 s100, s59, 20480
  buffer_load_dwordx4 v[140:143], v2, s[32:35], s100 offen offset:3072 sc1
  v_add_f32 v9, 0x3727c5ac, v9
  v_rsq_f32 v9, v9
  s_nop 0
  v_mul_f32 v11, v9, v9
  v_mul_f32 v10, s78, v9
  v_mul_f32 v12, v11, v9
  v_mul_f32 v12, s79, v12
  v_rcp_f32 v11, v11
  ds_read_b128 v[64:67], v6 offset:0
  ds_read_b128 v[68:71], v6 offset:32
  ds_read_b128 v[72:75], v6 offset:64
  ds_read_b128 v[76:79], v6 offset:96
  s_waitcnt lgkmcnt(0)
  v_fma_f32 v16, v8, v64, v16
  v_fma_f32 v17, v8, v65, v17
  v_fma_f32 v18, v8, v66, v18
  v_fma_f32 v19, v8, v67, v19
  s_add_u32 s100, s59, 24576
  buffer_load_dwordx4 v[144:147], v2, s[32:35], s100 offen offset:0 sc1
  v_fma_f32 v20, v8, v68, v20
  v_fma_f32 v21, v8, v69, v21
  v_fma_f32 v22, v8, v70, v22
  v_fma_f32 v23, v8, v71, v23
  v_fma_f32 v24, v8, v72, v24
  v_fma_f32 v25, v8, v73, v25
  v_fma_f32 v26, v8, v74, v26
  v_fma_f32 v27, v8, v75, v27
  v_fma_f32 v28, v8, v76, v28
  v_fma_f32 v29, v8, v77, v29
  v_fma_f32 v30, v8, v78, v30
  v_fma_f32 v31, v8, v79, v31
  ds_read_b128 v[64:67], v6 offset:128
  ds_read_b128 v[68:71], v6 offset:160
  ds_read_b128 v[72:75], v6 offset:192
  ds_read_b128 v[76:79], v6 offset:224
  v_mul_f32 v80, v16, v16
  s_add_u32 s100, s59, 24576
  buffer_load_dwordx4 v[148:151], v2, s[32:35], s100 offen offset:1024 sc1
  v_mul_f32 v81, v17, v17
  v_mul_f32 v82, v18, v18
  v_mul_f32 v83, v19, v19
  v_mul_f32 v84, v20, v20
  v_mul_f32 v85, v21, v21
  v_mul_f32 v86, v22, v22
  v_mul_f32 v87, v23, v23
  v_fma_f32 v80, v80, v12, v10
  v_fma_f32 v81, v81, v12, v10
  v_fma_f32 v82, v82, v12, v10
  v_fma_f32 v83, v83, v12, v10
  v_fma_f32 v84, v84, v12, v10
  v_fma_f32 v85, v85, v12, v10
  v_fma_f32 v86, v86, v12, v10
  v_fma_f32 v87, v87, v12, v10
  s_add_u32 s100, s59, 24576
  buffer_load_dwordx4 v[152:155], v2, s[32:35], s100 offen offset:2048 sc1
  v_mul_f32 v80, v80, v16
  v_mul_f32 v81, v81, v17
  v_mul_f32 v82, v82, v18
  v_mul_f32 v83, v83, v19
  v_mul_f32 v84, v84, v20
  v_mul_f32 v85, v85, v21
  v_mul_f32 v86, v86, v22
  v_mul_f32 v87, v87, v23
  v_exp_f32 v80, v80
  v_exp_f32 v81, v81
  v_exp_f32 v82, v82
  v_exp_f32 v83, v83
  s_add_u32 s100, s59, 24576
  buffer_load_dwordx4 v[156:159], v2, s[32:35], s100 offen offset:3072 sc1
  v_exp_f32 v84, v84
  v_exp_f32 v85, v85
  v_exp_f32 v86, v86
  v_exp_f32 v87, v87
  v_mul_f32 v16, v16, v24
  v_mul_f32 v17, v17, v25
  v_mul_f32 v18, v18, v26
  v_mul_f32 v19, v19, v27
  v_mul_f32 v20, v20, v28
  v_mul_f32 v21, v21, v29
  v_mul_f32 v22, v22, v30
  s_add_u32 s100, s59, 28672
  buffer_load_dwordx4 v[160:163], v2, s[32:35], s100 offen offset:0 sc1
  v_mul_f32 v23, v23, v31
  v_fma_f32 v80, v80, v11, v11
  v_fma_f32 v81, v81, v11, v11
  v_fma_f32 v82, v82, v11, v11
  v_fma_f32 v83, v83, v11, v11
  v_fma_f32 v84, v84, v11, v11
  v_fma_f32 v85, v85, v11, v11
  v_fma_f32 v86, v86, v11, v11
  v_fma_f32 v87, v87, v11, v11
  v_rcp_f32 v80, v80
  v_rcp_f32 v81, v81
  v_rcp_f32 v82, v82
  s_add_u32 s100, s59, 28672
  buffer_load_dwordx4 v[164:167], v2, s[32:35], s100 offen offset:1024 sc1
  v_rcp_f32 v83, v83
  v_rcp_f32 v84, v84
  v_rcp_f32 v85, v85
  v_rcp_f32 v86, v86
  v_rcp_f32 v87, v87
  v_mul_f32 v16, v16, v80
  v_mul_f32 v17, v17, v81
  v_mul_f32 v18, v18, v82
  v_mul_f32 v19, v19, v83
  v_mul_f32 v20, v20, v84
  v_mul_f32 v21, v21, v85
  v_mul_f32 v22, v22, v86
  v_mul_f32 v23, v23, v87
  v_cvt_pk_bf16_f32 v24, v16, v17
  v_cvt_pk_bf16_f32 v25, v18, v19
  v_cvt_pk_bf16_f32 v26, v20, v21
  v_cvt_pk_bf16_f32 v27, v22, v23
  buffer_store_dwordx4 v[24:27], v2, s[32:35], s66 offen offset:0 sc1
  s_waitcnt lgkmcnt(0)
  v_fma_f32 v32, v8, v64, v32
  v_fma_f32 v33, v8, v65, v33
  v_fma_f32 v34, v8, v66, v34
  v_fma_f32 v35, v8, v67, v35
  v_fma_f32 v36, v8, v68, v36
  v_fma_f32 v37, v8, v69, v37
  v_fma_f32 v38, v8, v70, v38
  v_fma_f32 v39, v8, v71, v39
  v_fma_f32 v40, v8, v72, v40
  v_fma_f32 v41, v8, v73, v41
  v_fma_f32 v42, v8, v74, v42
  v_fma_f32 v43, v8, v75, v43
  v_fma_f32 v44, v8, v76, v44
  v_fma_f32 v45, v8, v77, v45
  v_fma_f32 v46, v8, v78, v46
  v_fma_f32 v47, v8, v79, v47
  ds_read_b128 v[64:67], v6 offset:256
  ds_read_b128 v[68:71], v6 offset:288
  ds_read_b128 v[72:75], v6 offset:320
  ds_read_b128 v[76:79], v6 offset:352
  v_mul_f32 v80, v32, v32
  v_mul_f32 v81, v33, v33
  v_mul_f32 v82, v34, v34
  v_mul_f32 v83, v35, v35
  v_mul_f32 v84, v36, v36
  v_mul_f32 v85, v37, v37
  v_mul_f32 v86, v38, v38
  v_mul_f32 v87, v39, v39
  v_fma_f32 v80, v80, v12, v10
  v_fma_f32 v81, v81, v12, v10
  v_fma_f32 v82, v82, v12, v10
  v_fma_f32 v83, v83, v12, v10
  v_fma_f32 v84, v84, v12, v10
  v_fma_f32 v85, v85, v12, v10
  v_fma_f32 v86, v86, v12, v10
  v_fma_f32 v87, v87, v12, v10
  v_mul_f32 v80, v80, v32
  v_mul_f32 v81, v81, v33
  v_mul_f32 v82, v82, v34
  v_mul_f32 v83, v83, v35
  v_mul_f32 v84, v84, v36
  v_mul_f32 v85, v85, v37
  v_mul_f32 v86, v86, v38
  v_mul_f32 v87, v87, v39
  v_exp_f32 v80, v80
  v_exp_f32 v81, v81
  v_exp_f32 v82, v82
  v_exp_f32 v83, v83
  v_exp_f32 v84, v84
  v_exp_f32 v85, v85
  v_exp_f32 v86, v86
  v_exp_f32 v87, v87
  v_mul_f32 v32, v32, v40
  v_mul_f32 v33, v33, v41
  v_mul_f32 v34, v34, v42
  v_mul_f32 v35, v35, v43
  v_mul_f32 v36, v36, v44
  v_mul_f32 v37, v37, v45
  v_mul_f32 v38, v38, v46
  v_mul_f32 v39, v39, v47
  v_fma_f32 v80, v80, v11, v11
  v_fma_f32 v81, v81, v11, v11
  v_fma_f32 v82, v82, v11, v11
  v_fma_f32 v83, v83, v11, v11
  v_fma_f32 v84, v84, v11, v11
  v_fma_f32 v85, v85, v11, v11
  v_fma_f32 v86, v86, v11, v11
  v_fma_f32 v87, v87, v11, v11
  v_rcp_f32 v80, v80
  v_rcp_f32 v81, v81
  v_rcp_f32 v82, v82
  v_rcp_f32 v83, v83
  v_rcp_f32 v84, v84
  v_rcp_f32 v85, v85
  v_rcp_f32 v86, v86
  v_rcp_f32 v87, v87
  v_mul_f32 v32, v32, v80
  v_mul_f32 v33, v33, v81
  v_mul_f32 v34, v34, v82
  v_mul_f32 v35, v35, v83
  v_mul_f32 v36, v36, v84
  v_mul_f32 v37, v37, v85
  v_mul_f32 v38, v38, v86
  v_mul_f32 v39, v39, v87
  v_cvt_pk_bf16_f32 v40, v32, v33
  v_cvt_pk_bf16_f32 v41, v34, v35
  v_cvt_pk_bf16_f32 v42, v36, v37
  v_cvt_pk_bf16_f32 v43, v38, v39
  buffer_store_dwordx4 v[40:43], v2, s[32:35], s66 offen offset:1024 sc1
  s_waitcnt lgkmcnt(0)
  v_fma_f32 v48, v8, v64, v48
  v_fma_f32 v49, v8, v65, v49
  v_fma_f32 v50, v8, v66, v50
  v_fma_f32 v51, v8, v67, v51
  v_fma_f32 v52, v8, v68, v52
  v_fma_f32 v53, v8, v69, v53
  v_fma_f32 v54, v8, v70, v54
  v_fma_f32 v55, v8, v71, v55
  v_fma_f32 v56, v8, v72, v56
  v_fma_f32 v57, v8, v73, v57
  v_fma_f32 v58, v8, v74, v58
  v_fma_f32 v59, v8, v75, v59
  v_fma_f32 v60, v8, v76, v60
  v_fma_f32 v61, v8, v77, v61
  v_fma_f32 v62, v8, v78, v62
  v_fma_f32 v63, v8, v79, v63
  v_mul_f32 v80, v48, v48
  v_mul_f32 v81, v49, v49
  v_mul_f32 v82, v50, v50
  v_mul_f32 v83, v51, v51
  v_mul_f32 v84, v52, v52
  v_mul_f32 v85, v53, v53
  v_mul_f32 v86, v54, v54
  v_mul_f32 v87, v55, v55
  v_fma_f32 v80, v80, v12, v10
  v_fma_f32 v81, v81, v12, v10
  v_fma_f32 v82, v82, v12, v10
  v_fma_f32 v83, v83, v12, v10
  v_fma_f32 v84, v84, v12, v10
  v_fma_f32 v85, v85, v12, v10
  v_fma_f32 v86, v86, v12, v10
  v_fma_f32 v87, v87, v12, v10
  v_mul_f32 v80, v80, v48
  v_mul_f32 v81, v81, v49
  v_mul_f32 v82, v82, v50
  v_mul_f32 v83, v83, v51
  v_mul_f32 v84, v84, v52
  v_mul_f32 v85, v85, v53
  v_mul_f32 v86, v86, v54
  v_mul_f32 v87, v87, v55
  v_exp_f32 v80, v80
  v_exp_f32 v81, v81
  v_exp_f32 v82, v82
  v_exp_f32 v83, v83
  v_exp_f32 v84, v84
  v_exp_f32 v85, v85
  v_exp_f32 v86, v86
  v_exp_f32 v87, v87
  v_mul_f32 v48, v48, v56
  v_mul_f32 v49, v49, v57
  v_mul_f32 v50, v50, v58
  v_mul_f32 v51, v51, v59
  v_mul_f32 v52, v52, v60
  v_mul_f32 v53, v53, v61
  v_mul_f32 v54, v54, v62
  v_mul_f32 v55, v55, v63
  v_fma_f32 v80, v80, v11, v11
  v_fma_f32 v81, v81, v11, v11
  v_fma_f32 v82, v82, v11, v11
  v_fma_f32 v83, v83, v11, v11
  v_fma_f32 v84, v84, v11, v11
  v_fma_f32 v85, v85, v11, v11
  v_fma_f32 v86, v86, v11, v11
  v_fma_f32 v87, v87, v11, v11
  v_rcp_f32 v80, v80
  v_rcp_f32 v81, v81
  v_rcp_f32 v82, v82
  v_rcp_f32 v83, v83
  v_rcp_f32 v84, v84
  v_rcp_f32 v85, v85
  v_rcp_f32 v86, v86
  v_rcp_f32 v87, v87
  v_mul_f32 v48, v48, v80
  v_mul_f32 v49, v49, v81
  v_mul_f32 v50, v50, v82
  v_mul_f32 v51, v51, v83
  v_mul_f32 v52, v52, v84
  v_mul_f32 v53, v53, v85
  v_mul_f32 v54, v54, v86
  v_mul_f32 v55, v55, v87
  v_cvt_pk_bf16_f32 v56, v48, v49
  v_cvt_pk_bf16_f32 v57, v50, v51
  v_cvt_pk_bf16_f32 v58, v52, v53
  v_cvt_pk_bf16_f32 v59, v54, v55
  buffer_store_dwordx4 v[56:59], v2, s[32:35], s66 offen offset:2048 sc1
  s_lshl_b32 s52, s90, 12
  s_lshl_b32 s53, s88, 7
  s_add_u32 s52, s52, s53
  s_add_u32 s52, s52, 21233664
  s_waitcnt vmcnt(0)
  v_mov_b32 v8, 1
  s_mov_b64 exec, 1
  buffer_store_dword v8, off, s[32:35], s52 sc1
  s_mov_b64 exec, -1
  s_setprio 0
  s_lshl_b32 s101, s86, 12
  s_lshl_b32 s52, s3, 9
  s_add_u32 s101, s101, s52
  s_add_u32 s101, s101, 21233664
  v_and_b32 v8, 3, v1
  v_lshlrev_b32 v8, 7, v8
  s_nop 2
prb_150:
  buffer_load_dword v9, v8, s[32:35], s101 offen sc1
  s_waitcnt vmcnt(0)
  v_cmp_eq_u32 vcc, 0, v9
  s_nop 4
  s_cbranch_vccz prbok_151
  s_sleep 6
  s_add_u32 s95, s95, 1
  s_cmp_gt_u32 s95, 20000
  s_cbranch_scc0 prb_150
prbok_151:
  s_add_u32 s100, s63, 0
  buffer_load_dwordx4 v[88:91], v7, s[32:35], s100 offen offset:0 sc1
  s_add_u32 s100, s63, 0
  buffer_load_dwordx4 v[92:95], v7, s[32:35], s100 offen offset:256 sc1
  s_add_u32 s100, s63, 0
  buffer_load_dwordx4 v[96:99], v7, s[32:35], s100 offen offset:2048 sc1
  s_add_u32 s100, s63, 0
  buffer_load_dwordx4 v[100:103], v7, s[32:35], s100 offen offset:2304 sc1
  s_add_u32 s100, s63, 4096
  buffer_load_dwordx4 v[104:107], v7, s[32:35], s100 offen offset:0 sc1
  s_add_u32 s100, s63, 4096
  buffer_load_dwordx4 v[108:111], v7, s[32:35], s100 offen offset:256 sc1
  s_add_u32 s100, s63, 4096
  buffer_load_dwordx4 v[112:115], v7, s[32:35], s100 offen offset:2048 sc1
  s_add_u32 s100, s63, 4096
  buffer_load_dwordx4 v[116:119], v7, s[32:35], s100 offen offset:2304 sc1
  s_add_u32 s100, s63, 8192
  buffer_load_dwordx4 v[120:123], v7, s[32:35], s100 offen offset:0 sc1
  s_add_u32 s100, s63, 8192
  buffer_load_dwordx4 v[124:127], v7, s[32:35], s100 offen offset:256 sc1
  s_add_u32 s100, s63, 8192
  buffer_load_dwordx4 v[128:131], v7, s[32:35], s100 offen offset:2048 sc1
  s_add_u32 s100, s63, 8192
  buffer_load_dwordx4 v[132:135], v7, s[32:35], s100 offen offset:2304 sc1
  v_mov_b32 v12, 2816
  s_nop 2
gw_152:
  ds_read_b32 v13, v12
  s_waitcnt lgkmcnt(0)
  v_readfirstlane_b32 s52, v13
  s_nop 1
  s_cmp_ge_u32 s52, 16
  s_nop 1
  s_cbranch_scc1 gwok_153
  s_sleep 1
  s_add_u32 s95, s95, 1
  s_cmp_gt_u32 s95, 1000000
  s_cbranch_scc0 gw_152
gwok_153:
s3j_95:
  v_bfe_u32 v12, v1, 4, 1
  v_mul_u32_u24 v12, 5120, v12
  v_lshrrev_b32 v13, 5, v1
  v_lshl_add_u32 v12, v13, 9, v12
  v_and_b32 v13, 15, v1
  v_lshl_add_u32 v5, v13, 4, v12
  v_and_b32 v12, 31, v1
  v_mul_u32_u24 v12, 1280, v12
  v_lshrrev_b32 v13, 5, v1
  v_lshl_add_u32 v14, v13, 4, v12
  s_mul_i32 s52, s3, 10240
  s_add_u32 s52, s52, 81920
  v_add_u32 v3, s52, v2
  s_mul_i32 s74, s86, 40960
  s_mul_i32 s53, s87, 5120
  s_add_u32 s74, s74, s53
  s_add_u32 s74, s74, 11010048
  s_mul_i32 s75, s86, 40960
  s_mul_i32 s53, s87, 160
  s_add_u32 s75, s75, s53
  s_sub_u32 s76, s3, 3
  s_max_i32 s76, s76, 0
  s_min_u32 s77, s3, 4
s5v_156:
  s_waitcnt vmcnt(10)
  v_mfma_f32_16x16x32_bf16 v[16:19], v[168:171], v[88:91], 0
  v_mfma_f32_16x16x32_bf16 v[20:23], v[172:175], v[88:91], 0
  v_mfma_f32_16x16x32_bf16 v[24:27], v[176:179], v[88:91], 0
  v_mfma_f32_16x16x32_bf16 v[28:31], v[180:183], v[88:91], 0
  v_mfma_f32_16x16x32_bf16 v[32:35], v[184:187], v[88:91], 0
  v_mfma_f32_16x16x32_bf16 v[36:39], v[168:171], v[92:95], 0
  v_mfma_f32_16x16x32_bf16 v[40:43], v[172:175], v[92:95], 0
  v_mfma_f32_16x16x32_bf16 v[44:47], v[176:179], v[92:95], 0
  v_mfma_f32_16x16x32_bf16 v[48:51], v[180:183], v[92:95], 0
  v_mfma_f32_16x16x32_bf16 v[52:55], v[184:187], v[92:95], 0
  s_waitcnt vmcnt(8)
  v_mfma_f32_16x16x32_bf16 v[16:19], v[188:191], v[96:99], v[16:19]
  v_mfma_f32_16x16x32_bf16 v[20:23], v[192:195], v[96:99], v[20:23]
  v_mfma_f32_16x16x32_bf16 v[24:27], v[196:199], v[96:99], v[24:27]
  v_mfma_f32_16x16x32_bf16 v[28:31], v[200:203], v[96:99], v[28:31]
  v_mfma_f32_16x16x32_bf16 v[32:35], v[204:207], v[96:99], v[32:35]
  v_mfma_f32_16x16x32_bf16 v[36:39], v[188:191], v[100:103], v[36:39]
  v_mfma_f32_16x16x32_bf16 v[40:43], v[192:195], v[100:103], v[40:43]
  v_mfma_f32_16x16x32_bf16 v[44:47], v[196:199], v[100:103], v[44:47]
  v_mfma_f32_16x16x32_bf16 v[48:51], v[200:203], v[100:103], v[48:51]
  v_mfma_f32_16x16x32_bf16 v[52:55], v[204:207], v[100:103], v[52:55]
  s_waitcnt vmcnt(6)
  v_mfma_f32_16x16x32_bf16 v[16:19], v[208:211], v[104:107], v[16:19]
  v_mfma_f32_16x16x32_bf16 v[20:23], v[212:215], v[104:107], v[20:23]
  v_mfma_f32_16x16x32_bf16 v[24:27], v[216:219], v[104:107], v[24:27]
  v_mfma_f32_16x16x32_bf16 v[28:31], v[220:223], v[104:107], v[28:31]
  v_mfma_f32_16x16x32_bf16 v[32:35], v[224:227], v[104:107], v[32:35]
  v_mfma_f32_16x16x32_bf16 v[36:39], v[208:211], v[108:111], v[36:39]
  v_mfma_f32_16x16x32_bf16 v[40:43], v[212:215], v[108:111], v[40:43]
  v_mfma_f32_16x16x32_bf16 v[44:47], v[216:219], v[108:111], v[44:47]
  v_mfma_f32_16x16x32_bf16 v[48:51], v[220:223], v[108:111], v[48:51]
  v_mfma_f32_16x16x32_bf16 v[52:55], v[224:227], v[108:111], v[52:55]
  s_waitcnt vmcnt(4)
  v_mfma_f32_16x16x32_bf16 v[16:19], v[228:231], v[112:115], v[16:19]
  v_mfma_f32_16x16x32_bf16 v[20:23], v[232:235], v[112:115], v[20:23]
  v_mfma_f32_16x16x32_bf16 v[24:27], v[236:239], v[112:115], v[24:27]
  v_mfma_f32_16x16x32_bf16 v[28:31], v[240:243], v[112:115], v[28:31]
  v_mfma_f32_16x16x32_bf16 v[32:35], v[244:247], v[112:115], v[32:35]
  v_mfma_f32_16x16x32_bf16 v[36:39], v[228:231], v[116:119], v[36:39]
  v_mfma_f32_16x16x32_bf16 v[40:43], v[232:235], v[116:119], v[40:43]
  v_mfma_f32_16x16x32_bf16 v[44:47], v[236:239], v[116:119], v[44:47]
  v_mfma_f32_16x16x32_bf16 v[48:51], v[240:243], v[116:119], v[48:51]
  v_mfma_f32_16x16x32_bf16 v[52:55], v[244:247], v[116:119], v[52:55]
  s_waitcnt vmcnt(2)
  v_mfma_f32_16x16x32_bf16 v[16:19], v[248:251], v[120:123], v[16:19]
  v_mfma_f32_16x16x32_bf16 v[20:23], v[252:255], v[120:123], v[20:23]
  v_mfma_f32_16x16x32_bf16 v[24:27], v[136:139], v[120:123], v[24:27]
  v_mfma_f32_16x16x32_bf16 v[28:31], v[140:143], v[120:123], v[28:31]
  v_mfma_f32_16x16x32_bf16 v[32:35], v[144:147], v[120:123], v[32:35]
  v_mfma_f32_16x16x32_bf16 v[36:39], v[248:251], v[124:127], v[36:39]
  v_mfma_f32_16x16x32_bf16 v[40:43], v[252:255], v[124:127], v[40:43]
  v_mfma_f32_16x16x32_bf16 v[44:47], v[136:139], v[124:127], v[44:47]
  v_mfma_f32_16x16x32_bf16 v[48:51], v[140:143], v[124:127], v[48:51]
  v_mfma_f32_16x16x32_bf16 v[52:55], v[144:147], v[124:127], v[52:55]
  s_waitcnt vmcnt(0)
  v_mfma_f32_16x16x32_bf16 v[16:19], v[148:151], v[128:131], v[16:19]
  v_mfma_f32_16x16x32_bf16 v[20:23], v[152:155], v[128:131], v[20:23]
  v_mfma_f32_16x16x32_bf16 v[24:27], v[156:159], v[128:131], v[24:27]
  v_mfma_f32_16x16x32_bf16 v[28:31], v[160:163], v[128:131], v[28:31]
  v_mfma_f32_16x16x32_bf16 v[32:35], v[164:167], v[128:131], v[32:35]
  v_mfma_f32_16x16x32_bf16 v[36:39], v[148:151], v[132:135], v[36:39]
  v_mfma_f32_16x16x32_bf16 v[40:43], v[152:155], v[132:135], v[40:43]
  v_mfma_f32_16x16x32_bf16 v[44:47], v[156:159], v[132:135], v[44:47]
  v_mfma_f32_16x16x32_bf16 v[48:51], v[160:163], v[132:135], v[48:51]
  v_mfma_f32_16x16x32_bf16 v[52:55], v[164:167], v[132:135], v[52:55]
  s_cmp_ge_u32 s3, 4
  s_nop 6
  s_cbranch_scc1 s5g1_154
  s_barrier
  ds_write_b128 v3, v[16:19] offset:0
  ds_write_b128 v3, v[20:23] offset:1024
  ds_write_b128 v3, v[24:27] offset:2048
  ds_write_b128 v3, v[28:31] offset:3072
  ds_write_b128 v3, v[32:35] offset:4096
  ds_write_b128 v3, v[36:39] offset:5120
  ds_write_b128 v3, v[40:43] offset:6144
  ds_write_b128 v3, v[44:47] offset:7168
  ds_write_b128 v3, v[48:51] offset:8192
  ds_write_b128 v3, v[52:55] offset:9216
  s_waitcnt lgkmcnt(0)
  s_branch s5j_155
s5g1_154:
  ds_write_b128 v3, v[16:19] offset:0
  ds_write_b128 v3, v[20:23] offset:1024
  ds_write_b128 v3, v[24:27] offset:2048
  ds_write_b128 v3, v[28:31] offset:3072
  ds_write_b128 v3, v[32:35] offset:4096
  ds_write_b128 v3, v[36:39] offset:5120
  ds_write_b128 v3, v[40:43] offset:6144
  ds_write_b128 v3, v[44:47] offset:7168
  ds_write_b128 v3, v[48:51] offset:8192
  ds_write_b128 v3, v[52:55] offset:9216
  s_waitcnt lgkmcnt(0)
  s_barrier
s5j_155:
  s_lshl_b32 s52, s76, 10
  s_add_u32 s52, s52, s74
  buffer_load_dwordx4 v[104:107], v2, s[32:35], s52 offen sc1
  s_lshl_b32 s52, s77, 10
  s_add_u32 s52, s52, s74
  s_add_u32 s52, s52, 1310720
  buffer_load_dwordx4 v[8:11], v2, s[32:35], s52 offen sc1
  s_lshl_b32 s101, s86, 12
  s_lshl_b32 s52, s3, 9
  s_add_u32 s101, s101, s52
  s_add_u32 s101, s101, 21364736
  v_and_b32 v12, 3, v1
  v_lshlrev_b32 v12, 7, v12
  s_nop 2
prb_157:
  buffer_load_dword v13, v12, s[32:35], s101 offen sc1
  s_waitcnt vmcnt(0)
  v_cmp_eq_u32 vcc, 0, v13
  s_nop 4
  s_cbranch_vccz prbok_158
  s_sleep 8
  s_add_u32 s95, s95, 1
  s_cmp_gt_u32 s95, 20000
  s_cbranch_scc0 prb_157
prbok_158:
  s_add_u32 s100, s64, 0
  buffer_load_dwordx4 v[56:59], v7, s[32:35], s100 offen offset:0 sc1
  s_add_u32 s100, s64, 0
  buffer_load_dwordx4 v[60:63], v7, s[32:35], s100 offen offset:256 sc1
  s_add_u32 s100, s64, 0
  buffer_load_dwordx4 v[64:67], v7, s[32:35], s100 offen offset:2048 sc1
  s_add_u32 s100, s64, 0
  buffer_load_dwordx4 v[68:71], v7, s[32:35], s100 offen offset:2304 sc1
  s_add_u32 s100, s64, 4096
  buffer_load_dwordx4 v[72:75], v7, s[32:35], s100 offen offset:0 sc1
  s_add_u32 s100, s64, 4096
  buffer_load_dwordx4 v[76:79], v7, s[32:35], s100 offen offset:256 sc1
  s_add_u32 s100, s64, 4096
  buffer_load_dwordx4 v[80:83], v7, s[32:35], s100 offen offset:2048 sc1
  s_add_u32 s100, s64, 4096
  buffer_load_dwordx4 v[84:87], v7, s[32:35], s100 offen offset:2304 sc1
  s_add_u32 s100, s64, 8192
  buffer_load_dwordx4 v[88:91], v7, s[32:35], s100 offen offset:0 sc1
  s_add_u32 s100, s64, 8192
  buffer_load_dwordx4 v[92:95], v7, s[32:35], s100 offen offset:256 sc1
  s_add_u32 s100, s64, 8192
  buffer_load_dwordx4 v[96:99], v7, s[32:35], s100 offen offset:2048 sc1
  s_add_u32 s100, s64, 8192
  buffer_load_dwordx4 v[100:103], v7, s[32:35], s100 offen offset:2304 sc1
  s_barrier
  s_cmp_lt_u32 s3, 3
  s_cbranch_scc1 f4_159
  s_lshl_b32 s52, s76, 10
  s_add_u32 s52, s52, 81920
  v_add_u32 v4, s52, v5
  ds_read_b128 v[24:27], v4 offset:0
  ds_read_b128 v[28:31], v4 offset:256
  ds_read_b128 v[32:35], v4 offset:10240
  ds_read_b128 v[36:39], v4 offset:10496
  ds_read_b128 v[40:43], v4 offset:20480
  ds_read_b128 v[44:47], v4 offset:20736
  ds_read_b128 v[48:51], v4 offset:30720
  ds_read_b128 v[52:55], v4 offset:30976
  s_waitcnt lgkmcnt(0)
  v_add_f32 v24, v24, v32
  v_add_f32 v40, v40, v48
  v_add_f32 v16, v24, v40
  v_add_f32 v25, v25, v33
  v_add_f32 v41, v41, v49
  v_add_f32 v17, v25, v41
  v_add_f32 v26, v26, v34
  v_add_f32 v42, v42, v50
  v_add_f32 v18, v26, v42
  v_add_f32 v27, v27, v35
  v_add_f32 v43, v43, v51
  v_add_f32 v19, v27, v43
  v_add_f32 v28, v28, v36
  v_add_f32 v44, v44, v52
  v_add_f32 v20, v28, v44
  v_add_f32 v29, v29, v37
  v_add_f32 v45, v45, v53
  v_add_f32 v21, v29, v45
  v_add_f32 v30, v30, v38
  v_add_f32 v46, v46, v54
  v_add_f32 v22, v30, v46
  v_add_f32 v31, v31, v39
  v_add_f32 v47, v47, v55
  v_add_f32 v23, v31, v47
  ds_read_b128 v[24:27], v4 offset:40960
  ds_read_b128 v[28:31], v4 offset:41216
  ds_read_b128 v[32:35], v4 offset:51200
  ds_read_b128 v[36:39], v4 offset:51456
  ds_read_b128 v[40:43], v4 offset:61440
  ds_read_b128 v[44:47], v4 offset:61696
  v_add_u32 v12, 40960, v4
  ds_read_b128 v[48:51], v12 offset:30720
  v_add_u32 v12, 40960, v4
  ds_read_b128 v[52:55], v12 offset:30976
  s_waitcnt lgkmcnt(0)
  v_add_f32 v24, v24, v32
  v_add_f32 v40, v40, v48
  v_add_f32 v16, v16, v24
  v_add_f32 v16, v16, v40
  v_add_f32 v25, v25, v33
  v_add_f32 v41, v41, v49
  v_add_f32 v17, v17, v25
  v_add_f32 v17, v17, v41
  v_add_f32 v26, v26, v34
  v_add_f32 v42, v42, v50
  v_add_f32 v18, v18, v26
  v_add_f32 v18, v18, v42
  v_add_f32 v27, v27, v35
  v_add_f32 v43, v43, v51
  v_add_f32 v19, v19, v27
  v_add_f32 v19, v19, v43
  v_add_f32 v28, v28, v36
  v_add_f32 v44, v44, v52
  v_add_f32 v20, v20, v28
  v_add_f32 v20, v20, v44
  v_add_f32 v29, v29, v37
  v_add_f32 v45, v45, v53
  v_add_f32 v21, v21, v29
  v_add_f32 v21, v21, v45
  v_add_f32 v30, v30, v38
  v_add_f32 v46, v46, v54
  v_add_f32 v22, v22, v30
  v_add_f32 v22, v22, v46
  v_add_f32 v31, v31, v39
  v_add_f32 v47, v47, v55
  v_add_f32 v23, v23, v31
  v_add_f32 v23, v23, v47
  v_lshlrev_b32 v12, 16, v104
  v_add_f32 v16, v16, v12
  v_and_b32 v12, 0xffff0000, v104
  v_add_f32 v17, v17, v12
  v_lshlrev_b32 v12, 16, v105
  v_add_f32 v18, v18, v12
  v_and_b32 v12, 0xffff0000, v105
  v_add_f32 v19, v19, v12
  v_lshlrev_b32 v12, 16, v106
  v_add_f32 v20, v20, v12
  v_and_b32 v12, 0xffff0000, v106
  v_add_f32 v21, v21, v12
  v_lshlrev_b32 v12, 16, v107
  v_add_f32 v22, v22, v12
  v_and_b32 v12, 0xffff0000, v107
  v_add_f32 v23, v23, v12
  v_cvt_pk_bf16_f32 v24, v16, v17
  v_cvt_pk_bf16_f32 v25, v18, v19
  v_cvt_pk_bf16_f32 v26, v20, v21
  v_cvt_pk_bf16_f32 v27, v22, v23
  s_lshl_b32 s52, s76, 5
  s_add_u32 s52, s52, s75
  buffer_store_dwordx4 v[24:27], v14, s[36:39], s52 offen
  s_nop 1
f4_159:
  v_subrev_u32 v3, 81920, v3
  s_nop 2
s5v_160:
  s_waitcnt vmcnt(10)
  v_mfma_f32_16x16x32_bf16 v[16:19], v[168:171], v[56:59], 0
  v_mfma_f32_16x16x32_bf16 v[20:23], v[172:175], v[56:59], 0
  v_mfma_f32_16x16x32_bf16 v[24:27], v[176:179], v[56:59], 0
  v_mfma_f32_16x16x32_bf16 v[28:31], v[180:183], v[56:59], 0
  v_mfma_f32_16x16x32_bf16 v[32:35], v[184:187], v[56:59], 0
  v_mfma_f32_16x16x32_bf16 v[36:39], v[168:171], v[60:63], 0
  v_mfma_f32_16x16x32_bf16 v[40:43], v[172:175], v[60:63], 0
  v_mfma_f32_16x16x32_bf16 v[44:47], v[176:179], v[60:63], 0
  v_mfma_f32_16x16x32_bf16 v[48:51], v[180:183], v[60:63], 0
  v_mfma_f32_16x16x32_bf16 v[52:55], v[184:187], v[60:63], 0
  s_waitcnt vmcnt(8)
  v_mfma_f32_16x16x32_bf16 v[16:19], v[188:191], v[64:67], v[16:19]
  v_mfma_f32_16x16x32_bf16 v[20:23], v[192:195], v[64:67], v[20:23]
  v_mfma_f32_16x16x32_bf16 v[24:27], v[196:199], v[64:67], v[24:27]
  v_mfma_f32_16x16x32_bf16 v[28:31], v[200:203], v[64:67], v[28:31]
  v_mfma_f32_16x16x32_bf16 v[32:35], v[204:207], v[64:67], v[32:35]
  v_mfma_f32_16x16x32_bf16 v[36:39], v[188:191], v[68:71], v[36:39]
  v_mfma_f32_16x16x32_bf16 v[40:43], v[192:195], v[68:71], v[40:43]
  v_mfma_f32_16x16x32_bf16 v[44:47], v[196:199], v[68:71], v[44:47]
  v_mfma_f32_16x16x32_bf16 v[48:51], v[200:203], v[68:71], v[48:51]
  v_mfma_f32_16x16x32_bf16 v[52:55], v[204:207], v[68:71], v[52:55]
  s_waitcnt vmcnt(6)
  v_mfma_f32_16x16x32_bf16 v[16:19], v[208:211], v[72:75], v[16:19]
  v_mfma_f32_16x16x32_bf16 v[20:23], v[212:215], v[72:75], v[20:23]
  v_mfma_f32_16x16x32_bf16 v[24:27], v[216:219], v[72:75], v[24:27]
  v_mfma_f32_16x16x32_bf16 v[28:31], v[220:223], v[72:75], v[28:31]
  v_mfma_f32_16x16x32_bf16 v[32:35], v[224:227], v[72:75], v[32:35]
  v_mfma_f32_16x16x32_bf16 v[36:39], v[208:211], v[76:79], v[36:39]
  v_mfma_f32_16x16x32_bf16 v[40:43], v[212:215], v[76:79], v[40:43]
  v_mfma_f32_16x16x32_bf16 v[44:47], v[216:219], v[76:79], v[44:47]
  v_mfma_f32_16x16x32_bf16 v[48:51], v[220:223], v[76:79], v[48:51]
  v_mfma_f32_16x16x32_bf16 v[52:55], v[224:227], v[76:79], v[52:55]
  s_waitcnt vmcnt(4)
  v_mfma_f32_16x16x32_bf16 v[16:19], v[228:231], v[80:83], v[16:19]
  v_mfma_f32_16x16x32_bf16 v[20:23], v[232:235], v[80:83], v[20:23]
  v_mfma_f32_16x16x32_bf16 v[24:27], v[236:239], v[80:83], v[24:27]
  v_mfma_f32_16x16x32_bf16 v[28:31], v[240:243], v[80:83], v[28:31]
  v_mfma_f32_16x16x32_bf16 v[32:35], v[244:247], v[80:83], v[32:35]
  v_mfma_f32_16x16x32_bf16 v[36:39], v[228:231], v[84:87], v[36:39]
  v_mfma_f32_16x16x32_bf16 v[40:43], v[232:235], v[84:87], v[40:43]
  v_mfma_f32_16x16x32_bf16 v[44:47], v[236:239], v[84:87], v[44:47]
  v_mfma_f32_16x16x32_bf16 v[48:51], v[240:243], v[84:87], v[48:51]
  v_mfma_f32_16x16x32_bf16 v[52:55], v[244:247], v[84:87], v[52:55]
  s_waitcnt vmcnt(2)
  v_mfma_f32_16x16x32_bf16 v[16:19], v[248:251], v[88:91], v[16:19]
  v_mfma_f32_16x16x32_bf16 v[20:23], v[252:255], v[88:91], v[20:23]
  v_mfma_f32_16x16x32_bf16 v[24:27], v[136:139], v[88:91], v[24:27]
  v_mfma_f32_16x16x32_bf16 v[28:31], v[140:143], v[88:91], v[28:31]
  v_mfma_f32_16x16x32_bf16 v[32:35], v[144:147], v[88:91], v[32:35]
  v_mfma_f32_16x16x32_bf16 v[36:39], v[248:251], v[92:95], v[36:39]
  v_mfma_f32_16x16x32_bf16 v[40:43], v[252:255], v[92:95], v[40:43]
  v_mfma_f32_16x16x32_bf16 v[44:47], v[136:139], v[92:95], v[44:47]
  v_mfma_f32_16x16x32_bf16 v[48:51], v[140:143], v[92:95], v[48:51]
  v_mfma_f32_16x16x32_bf16 v[52:55], v[144:147], v[92:95], v[52:55]
  s_waitcnt vmcnt(0)
  v_mfma_f32_16x16x32_bf16 v[16:19], v[148:151], v[96:99], v[16:19]
  v_mfma_f32_16x16x32_bf16 v[20:23], v[152:155], v[96:99], v[20:23]
  v_mfma_f32_16x16x32_bf16 v[24:27], v[156:159], v[96:99], v[24:27]
  v_mfma_f32_16x16x32_bf16 v[28:31], v[160:163], v[96:99], v[28:31]
  v_mfma_f32_16x16x32_bf16 v[32:35], v[164:167], v[96:99], v[32:35]
  v_mfma_f32_16x16x32_bf16 v[36:39], v[148:151], v[100:103], v[36:39]
  v_mfma_f32_16x16x32_bf16 v[40:43], v[152:155], v[100:103], v[40:43]
  v_mfma_f32_16x16x32_bf16 v[44:47], v[156:159], v[100:103], v[44:47]
  v_mfma_f32_16x16x32_bf16 v[48:51], v[160:163], v[100:103], v[48:51]
  v_mfma_f32_16x16x32_bf16 v[52:55], v[164:167], v[100:103], v[52:55]
  ds_write_b128 v3, v[16:19] offset:0
  ds_write_b128 v3, v[20:23] offset:1024
  ds_write_b128 v3, v[24:27] offset:2048
  ds_write_b128 v3, v[28:31] offset:3072
  ds_write_b128 v3, v[32:35] offset:4096
  ds_write_b128 v3, v[36:39] offset:5120
  ds_write_b128 v3, v[40:43] offset:6144
  ds_write_b128 v3, v[44:47] offset:7168
  ds_write_b128 v3, v[48:51] offset:8192
  ds_write_b128 v3, v[52:55] offset:9216
  s_waitcnt lgkmcnt(0)
  s_barrier
  s_cmp_ge_u32 s3, 5
  s_cbranch_scc1 s5sk_161
  s_lshl_b32 s52, s3, 10
  s_add_u32 s52, s52, 0
  v_add_u32 v4, s52, v5
  ds_read_b128 v[24:27], v4 offset:0
  ds_read_b128 v[28:31], v4 offset:256
  ds_read_b128 v[32:35], v4 offset:10240
  ds_read_b128 v[36:39], v4 offset:10496
  ds_read_b128 v[40:43], v4 offset:20480
  ds_read_b128 v[44:47], v4 offset:20736
  ds_read_b128 v[48:51], v4 offset:30720
  ds_read_b128 v[52:55], v4 offset:30976
  s_waitcnt lgkmcnt(0)
  v_add_f32 v24, v24, v32
  v_add_f32 v40, v40, v48
  v_add_f32 v16, v24, v40
  v_add_f32 v25, v25, v33
  v_add_f32 v41, v41, v49
  v_add_f32 v17, v25, v41
  v_add_f32 v26, v26, v34
  v_add_f32 v42, v42, v50
  v_add_f32 v18, v26, v42
  v_add_f32 v27, v27, v35
  v_add_f32 v43, v43, v51
  v_add_f32 v19, v27, v43
  v_add_f32 v28, v28, v36
  v_add_f32 v44, v44, v52
  v_add_f32 v20, v28, v44
  v_add_f32 v29, v29, v37
  v_add_f32 v45, v45, v53
  v_add_f32 v21, v29, v45
  v_add_f32 v30, v30, v38
  v_add_f32 v46, v46, v54
  v_add_f32 v22, v30, v46
  v_add_f32 v31, v31, v39
  v_add_f32 v47, v47, v55
  v_add_f32 v23, v31, v47
  ds_read_b128 v[24:27], v4 offset:40960
  ds_read_b128 v[28:31], v4 offset:41216
  ds_read_b128 v[32:35], v4 offset:51200
  ds_read_b128 v[36:39], v4 offset:51456
  ds_read_b128 v[40:43], v4 offset:61440
  ds_read_b128 v[44:47], v4 offset:61696
  v_add_u32 v12, 40960, v4
  ds_read_b128 v[48:51], v12 offset:30720
  v_add_u32 v12, 40960, v4
  ds_read_b128 v[52:55], v12 offset:30976
  s_waitcnt lgkmcnt(0)
  v_add_f32 v24, v24, v32
  v_add_f32 v40, v40, v48
  v_add_f32 v16, v16, v24
  v_add_f32 v16, v16, v40
  v_add_f32 v25, v25, v33
  v_add_f32 v41, v41, v49
  v_add_f32 v17, v17, v25
  v_add_f32 v17, v17, v41
  v_add_f32 v26, v26, v34
  v_add_f32 v42, v42, v50
  v_add_f32 v18, v18, v26
  v_add_f32 v18, v18, v42
  v_add_f32 v27, v27, v35
  v_add_f32 v43, v43, v51
  v_add_f32 v19, v19, v27
  v_add_f32 v19, v19, v43
  v_add_f32 v28, v28, v36
  v_add_f32 v44, v44, v52
  v_add_f32 v20, v20, v28
  v_add_f32 v20, v20, v44
  v_add_f32 v29, v29, v37
  v_add_f32 v45, v45, v53
  v_add_f32 v21, v21, v29
  v_add_f32 v21, v21, v45
  v_add_f32 v30, v30, v38
  v_add_f32 v46, v46, v54
  v_add_f32 v22, v22, v30
  v_add_f32 v22, v22, v46
  v_add_f32 v31, v31, v39
  v_add_f32 v47, v47, v55
  v_add_f32 v23, v23, v31
  v_add_f32 v23, v23, v47
  v_lshlrev_b32 v12, 16, v8
  v_add_f32 v16, v16, v12
  v_and_b32 v12, 0xffff0000, v8
  v_add_f32 v17, v17, v12
  v_lshlrev_b32 v12, 16, v9
  v_add_f32 v18, v18, v12
  v_and_b32 v12, 0xffff0000, v9
  v_add_f32 v19, v19, v12
  v_lshlrev_b32 v12, 16, v10
  v_add_f32 v20, v20, v12
  v_and_b32 v12, 0xffff0000, v10
  v_add_f32 v21, v21, v12
  v_lshlrev_b32 v12, 16, v11
  v_add_f32 v22, v22, v12
  v_and_b32 v12, 0xffff0000, v11
  v_add_f32 v23, v23, v12
  v_cvt_pk_bf16_f32 v24, v16, v17
  v_cvt_pk_bf16_f32 v25, v18, v19
  v_cvt_pk_bf16_f32 v26, v20, v21
  v_cvt_pk_bf16_f32 v27, v22, v23
  s_lshl_b32 s52, s3, 5
  s_add_u32 s52, s52, s75
  s_add_u32 s52, s52, 1310720
  buffer_store_dwordx4 v[24:27], v14, s[36:39], s52 offen
  s_nop 1
s5sk_161:
  s_waitcnt vmcnt(0) lgkmcnt(0)
L_exit_kb_kernel:
  s_endpgm
L_end_of_code:
.section .rodata,"a"
.p2align 6
.amdhsa_kernel ka_kernel
  .amdhsa_next_free_vgpr 256
  .amdhsa_next_free_sgpr 102
  .amdhsa_accum_offset 256
  .amdhsa_group_segment_fixed_size 0
  .amdhsa_kernarg_size 80
  .amdhsa_user_sgpr_count 2
  .amdhsa_user_sgpr_kernarg_segment_ptr 1
  .amdhsa_system_sgpr_workgroup_id_x 1
.end_amdhsa_kernel
.section .rodata,"a"
.p2align 6
.amdhsa_kernel kb_kernel
  .amdhsa_next_free_vgpr 256
  .amdhsa_next_free_sgpr 102
  .amdhsa_accum_offset 256
  .amdhsa_group_segment_fixed_size 0
  .amdhsa_kernarg_size 80
  .amdhsa_user_sgpr_count 2
  .amdhsa_user_sgpr_kernarg_segment_ptr 1
  .amdhsa_system_sgpr_workgroup_id_x 1
.end_amdhsa_kernel
```
